```python
import torch

def _softmax(x, axis=-1):
    return torch.softmax(x, dim=axis)
def _gelu(x):
    return torch.nn.functional.gelu(x, approximate="tanh")
def _silu(x):
    return torch.nn.functional.silu(x)
def _sigmoid(x):
    return torch.sigmoid(x)
def _layernorm(x, axis=-1, eps=1e-5):
    m = x.mean(dim=axis, keepdim=True)
    v = x.var(dim=axis, keepdim=True, unbiased=False)
    return (x - m) / torch.sqrt(v + eps)
def _scatter_add(tgt, idx, src, axis=0):
    return tgt.clone().index_add_(axis, idx, src)
def _segment_sum(src, seg, n):
    out = torch.zeros((n,) + src.shape[1:], dtype=src.dtype)
    return out.index_add_(0, seg, src)
def _pad(x, pw):
    flat = tuple(v for pair in reversed(pw) for v in pair)
    return torch.nn.functional.pad(x, flat)

kernel_name = 'recurrent_scan__mha_block__glu_gated_swiglu__prompt'

def setup_inputs():

    _w = (lambda a: (lambda t: t.to(torch.bfloat16) if t.is_floating_point() else t)(torch.as_tensor(a)))
    def _A_setup():
        B, S, D, H = 1, 2048, 640, 32
        return {
            "x": _w((lambda *s: torch.randn(*s, dtype=torch.bfloat16) * 0.05)(B, S, D)),
            "wqkv": _w((lambda *s: torch.randn(*s, dtype=torch.bfloat16) * 0.2)(D, 3 * D)),
            "wo": _w((lambda *s: torch.randn(*s, dtype=torch.bfloat16) * 0.2)(D, D)),
        }
    _A_in = _A_setup()

    def _B_setup():
        B, S, D, F = 1, 2048, 640, 1536
        return {
            "x": _w((lambda *s: torch.randn(*s, dtype=torch.bfloat16) * 0.05)(B, S, D)),
            "w1": _w((lambda *s: torch.randn(*s, dtype=torch.bfloat16) * 0.1)(D, F) * (2.0 / D) ** 0.5),
            "w3": _w((lambda *s: torch.randn(*s, dtype=torch.bfloat16) * 0.1)(D, F) * (2.0 / D) ** 0.5),
            "w2": _w((lambda *s: torch.randn(*s, dtype=torch.bfloat16) * 0.1)(F, D) * (2.0 / F) ** 0.5),
        }
    _B_in = _B_setup()

    return {
        "A_x": _A_in["x"],
        "A_wqkv": _A_in["wqkv"],
        "A_wo": _A_in["wo"],
        "B_x": _B_in["x"],
        "B_w1": _B_in["w1"],
        "B_w3": _B_in["w3"],
        "B_w2": _B_in["w2"],
    }

def reference(A_x, A_wqkv, A_wo, B_x, B_w1, B_w3, B_w2):
    def _A_ref(x, wqkv, wo):
        B, S, D = x.shape
        H = 32
        Dh = D // H
        qkv = (lambda x, *d: x.permute(*d))((x @ wqkv).reshape(B, S, 3, H, Dh), 2, 0, 3, 1, 4)
        q, k, v = qkv[0], qkv[1], qkv[2]
        scores = torch.einsum("bhqd,bhkd->bhqk", q, k) * (Dh ** -0.5)
        p = _softmax(scores, axis=-1)
        o = torch.einsum("bhqk,bhkd->bhqd", p, v)
        return (lambda x, *d: x.permute(*d))(o, 0, 2, 1, 3).reshape(B, S, D) @ wo

    def _B_ref(x, w1, w3, w2):
        gate = torch.einsum("bsd,df->bsf", x, w1)
        up = torch.einsum("bsd,df->bsf", x, w3)
        h = _silu(gate) * up
        out = torch.einsum("bsf,fd->bsd", h, w2)
        return out

    x = A_x
    xn = _layernorm(x, axis=-1)
    s = _A_ref(xn, A_wqkv, A_wo)
    g = _silu(_B_ref(xn, B_w1, B_w3, B_w2))
    return x + s * g
```

```asm
; @launch kernel=k1_kernel grid=(256,1,1) block=(512,1,1) lds=157760
; @launch kernel=att_kernel grid=(512,1,1) block=(512,1,1) lds=81920
.amdgcn_target "amdgcn-amd-amdhsa--gfx950"
.text
.globl k1_kernel
.p2align 8
.type k1_kernel,@function
k1_kernel:

    s_cmp_ge_u32 s2, 256
    s_cbranch_scc1 K1_END
    s_load_dwordx2 s[34:35], s[0:1], 72
    s_load_dwordx2 s[36:37], s[0:1], 0
    s_load_dwordx2 s[38:39], s[0:1], 8
    s_load_dwordx4 s[40:43], s[0:1], 32
    s_load_dwordx2 s[50:51], s[0:1], 16
    s_load_dwordx2 s[52:53], s[0:1], 48
    v_lshrrev_b32 v58, 6, v0
    v_and_b32 v0, 63, v0
    v_readfirstlane_b32 s16, v58
    s_and_b32 s27, s2, 7
    s_lshr_b32 s29, s2, 3
    s_and_b32 s17, s27, 1
    s_lshl_b32 s17, s17, 3
    s_and_b32 s30, s29, 7
    s_add_u32 s17, s17, s30
    s_lshr_b32 s18, s27, 1
    s_lshl_b32 s18, s18, 2
    s_lshr_b32 s30, s29, 3
    s_add_u32 s18, s18, s30
    s_mov_b32 s30, 2553443856
    s_mov_b32 s31, 4275424164
    s_lshl_b32 s18, s18, 2
    s_lshr_b64 s[30:31], s[30:31], s18
    s_and_b32 s18, s30, 15
    s_cmp_ge_u32 s16, 4
    s_cbranch_scc1 K1_LOADER
    s_mul_i32 s27, s2, 10240
    s_add_u32 s27, s27, 7864320
    v_lshlrev_b32 v59, 4, v0
    v_mov_b32 v60, -1
    v_mov_b32 v61, -1
    v_mov_b32 v62, -1
    v_mov_b32 v63, -1
    s_lshl_b32 s28, s16, 10
    s_waitcnt lgkmcnt(0)
    s_add_u32 s4, s34, s27
    s_addc_u32 s5, s35, 0
    s_mov_b32 s6, 10240
    s_mov_b32 s7, 0x00020000
    buffer_store_dwordx4 v[60:63], v59, s[4:7], s28 offen sc1
    s_add_u32 s28, s28, 4096
    buffer_store_dwordx4 v[60:63], v59, s[4:7], s28 offen sc1
    s_add_u32 s28, s28, 4096
    buffer_store_dwordx4 v[60:63], v59, s[4:7], s28 offen sc1
    s_nop 3
    s_cmp_eq_u32 s16, 3
    s_cbranch_scc0 K1_CPE_END
    s_getpc_b64 s[4:5]
K1_CPE_PC:
    s_sub_u32 s4, s4, K1_CPE_PC-k1_kernel
    s_subb_u32 s5, s5, 0
    s_mov_b32 s6, FFN_TAIL+4-k1_kernel
    s_mov_b32 s7, 0x00020000
    v_lshlrev_b32 v52, 7, v0
    s_lshr_b32 s28, s2, 3
    s_mul_i32 s28, s28, 1152
    s_mov_b64 exec, 0x1ff
    buffer_load_dword v53, v52, s[4:7], s28 offen
    s_mov_b64 exec, -1
K1_CPE_END:
    s_lshr_b32 s19, s16, 1
    s_and_b32 s20, s16, 1
    s_xor_b32 s21, s19, s20
    s_mov_b32 s44, 20544
    s_mov_b32 s45, 4294885120
    s_mov_b32 s46, 16384
    s_mov_b32 s47, 4294934528
    v_and_b32 v58, 31, v0
    v_lshrrev_b32 v59, 5, v0
    v_bfe_u32 v60, v0, 1, 3
    v_lshlrev_b32 v61, 7, v58
    s_lshl_b32 s27, s19, 13
    v_add_u32 v61, s27, v61
    s_xor_b32 s27, s21, 0
    s_add_u32 s27, s27, 0
    s_lshl_b32 s27, s27, 1
    v_add_u32 v40, s27, v59
    v_xor_b32 v40, v40, v60
    v_lshlrev_b32 v40, 4, v40
    v_add_u32 v40, v40, v61
    s_xor_b32 s27, s21, 1
    s_add_u32 s27, s27, 0
    s_lshl_b32 s27, s27, 1
    v_add_u32 v41, s27, v59
    v_xor_b32 v41, v41, v60
    v_lshlrev_b32 v41, 4, v41
    v_add_u32 v41, v41, v61
    s_xor_b32 s27, s21, 0
    s_add_u32 s27, s27, 2
    s_lshl_b32 s27, s27, 1
    v_add_u32 v42, s27, v59
    v_xor_b32 v42, v42, v60
    v_lshlrev_b32 v42, 4, v42
    v_add_u32 v42, v42, v61
    s_xor_b32 s27, s21, 1
    s_add_u32 s27, s27, 2
    s_lshl_b32 s27, s27, 1
    v_add_u32 v43, s27, v59
    v_xor_b32 v43, v43, v60
    v_lshlrev_b32 v43, 4, v43
    v_add_u32 v43, v43, v61
    s_lshl_b32 s27, s19, 9
    s_add_u32 s27, s27, 156736
    v_lshlrev_b32 v63, 3, v58
    v_add_u32 v63, s27, v63
    v_mov_b32 v64, 0
    v_mov_b32 v65, 0
    v_mov_b32 v66, 0
    v_mov_b32 v67, 0
    v_mov_b32 v68, 0
    v_mov_b32 v69, 0
    v_mov_b32 v70, 0
    v_mov_b32 v71, 0
    v_mov_b32 v72, 0
    v_mov_b32 v73, 0
    v_mov_b32 v74, 0
    v_mov_b32 v75, 0
    v_mov_b32 v76, 0
    v_mov_b32 v77, 0
    v_mov_b32 v78, 0
    v_mov_b32 v79, 0
    v_mov_b32 v80, 0
    v_mov_b32 v81, 0
    v_mov_b32 v82, 0
    v_mov_b32 v83, 0
    v_and_b32 v59, 15, v0
    v_bfe_u32 v60, v0, 4, 1
    v_cmp_eq_u32 vcc, v59, v60
    v_mov_b32 v59, 0
    v_mov_b32 v60, 0x3f803f80
    v_cndmask_b32 v48, v59, v60, vcc
    v_cndmask_b32 v49, v59, v60, vcc
    v_cndmask_b32 v50, v59, v60, vcc
    v_cndmask_b32 v51, v59, v60, vcc
    s_mov_b32 s25, 0
    v_lshrrev_b32 v84, 5, v0
    v_bfe_u32 v85, v0, 4, 1
    v_bfe_u32 v86, v0, 2, 2
    v_and_b32 v87, 3, v0
    v_lshlrev_b32 v88, 3, v84
    v_add_u32 v88, v88, v86
    s_cmp_ge_u32 s18, 6
    s_cbranch_scc1 K1_FFN_SETUP
    v_mul_u32_u24 v59, 640, v88
    v_lshlrev_b32 v60, 5, v85
    v_add_u32 v59, v59, v60
    v_lshlrev_b32 v60, 3, v87
    v_add_u32 v59, v59, v60
    s_mul_i32 s27, s20, 320
    s_add_u32 s27, s27, 49152
    v_add_u32 v59, s27, v59
    v_lshrrev_b32 v60, 1, v86
    v_lshlrev_b32 v60, 6, v60
    v_sub_u32 v61, 0, v60
    s_cmp_eq_u32 s20, 0
    s_cselect_b64 vcc, -1, 0
    v_cndmask_b32 v89, v61, v60, vcc
    v_cndmask_b32 v90, v60, v61, vcc
    s_xor_b32 s27, s21, 0
    s_mul_i32 s27, s27, 10240
    v_add_u32 v60, s27, v59
    v_add_u32 v44, v60, v89
    v_add_u32 v45, v60, v90
    s_xor_b32 s27, s21, 1
    s_mul_i32 s27, s27, 10240
    v_add_u32 v60, s27, v59
    v_add_u32 v46, v60, v89
    v_add_u32 v47, v60, v90
    s_mul_i32 s27, s20, 640
    s_mul_i32 s29, s19, 1280
    s_add_u32 s27, s27, s29
    s_add_u32 s27, s27, 153152
    v_and_b32 v62, 15, v0
    v_lshlrev_b32 v62, 2, v62
    v_add_u32 v62, s27, v62
    v_mov_b32 v96, 0
    v_mov_b32 v97, 0
    v_mov_b32 v98, 0
    v_mov_b32 v99, 0
    v_mov_b32 v100, 0
    v_mov_b32 v101, 0
    v_mov_b32 v102, 0
    v_mov_b32 v103, 0
    v_mov_b32 v104, 0
    v_mov_b32 v105, 0
    v_mov_b32 v106, 0
    v_mov_b32 v107, 0
    v_mov_b32 v108, 0
    v_mov_b32 v109, 0
    v_mov_b32 v110, 0
    v_mov_b32 v111, 0
    v_mov_b32 v112, 0
    v_mov_b32 v113, 0
    v_mov_b32 v114, 0
    v_mov_b32 v115, 0
    v_mov_b32 v116, 0
    v_mov_b32 v117, 0
    v_mov_b32 v118, 0
    v_mov_b32 v119, 0
    v_mov_b32 v120, 0
    v_mov_b32 v121, 0
    v_mov_b32 v122, 0
    v_mov_b32 v123, 0
    v_mov_b32 v124, 0
    v_mov_b32 v125, 0
    v_mov_b32 v126, 0
    v_mov_b32 v127, 0
    v_mov_b32 v128, 0
    v_mov_b32 v129, 0
    v_mov_b32 v130, 0
    v_mov_b32 v131, 0
    v_mov_b32 v132, 0
    v_mov_b32 v133, 0
    v_mov_b32 v134, 0
    v_mov_b32 v135, 0
    v_mov_b32 v136, 0
    v_mov_b32 v137, 0
    v_mov_b32 v138, 0
    v_mov_b32 v139, 0
    v_mov_b32 v140, 0
    v_mov_b32 v141, 0
    v_mov_b32 v142, 0
    v_mov_b32 v143, 0
    v_mov_b32 v144, 0
    v_mov_b32 v145, 0
    v_mov_b32 v146, 0
    v_mov_b32 v147, 0
    v_mov_b32 v148, 0
    v_mov_b32 v149, 0
    v_mov_b32 v150, 0
    v_mov_b32 v151, 0
    v_mov_b32 v152, 0
    v_mov_b32 v153, 0
    v_mov_b32 v154, 0
    v_mov_b32 v155, 0
    v_mov_b32 v156, 0
    v_mov_b32 v157, 0
    v_mov_b32 v158, 0
    v_mov_b32 v159, 0
    v_mov_b32 v160, 0
    v_mov_b32 v161, 0
    v_mov_b32 v162, 0
    v_mov_b32 v163, 0
    v_mov_b32 v164, 0
    v_mov_b32 v165, 0
    v_mov_b32 v166, 0
    v_mov_b32 v167, 0
    v_mov_b32 v168, 0
    v_mov_b32 v169, 0
    v_mov_b32 v170, 0
    v_mov_b32 v171, 0
    v_mov_b32 v172, 0
    v_mov_b32 v173, 0
    v_mov_b32 v174, 0
    v_mov_b32 v175, 0
    v_mov_b32 v176, 0
    v_mov_b32 v177, 0
    v_mov_b32 v178, 0
    v_mov_b32 v179, 0
    v_mov_b32 v180, 0
    v_mov_b32 v181, 0
    v_mov_b32 v182, 0
    v_mov_b32 v183, 0
    v_mov_b32 v184, 0
    v_mov_b32 v185, 0
    v_mov_b32 v186, 0
    v_mov_b32 v187, 0
    v_mov_b32 v188, 0
    v_mov_b32 v189, 0
    v_mov_b32 v190, 0
    v_mov_b32 v191, 0
    v_mov_b32 v192, 0
    v_mov_b32 v193, 0
    v_mov_b32 v194, 0
    v_mov_b32 v195, 0
    v_mov_b32 v196, 0
    v_mov_b32 v197, 0
    v_mov_b32 v198, 0
    v_mov_b32 v199, 0
    v_mov_b32 v200, 0
    v_mov_b32 v201, 0
    v_mov_b32 v202, 0
    v_mov_b32 v203, 0
    v_mov_b32 v204, 0
    v_mov_b32 v205, 0
    v_mov_b32 v206, 0
    v_mov_b32 v207, 0
    v_mov_b32 v208, 0
    v_mov_b32 v209, 0
    v_mov_b32 v210, 0
    v_mov_b32 v211, 0
    v_mov_b32 v212, 0
    v_mov_b32 v213, 0
    v_mov_b32 v214, 0
    v_mov_b32 v215, 0
    v_mov_b32 v216, 0
    v_mov_b32 v217, 0
    v_mov_b32 v218, 0
    v_mov_b32 v219, 0
    v_mov_b32 v220, 0
    v_mov_b32 v221, 0
    v_mov_b32 v222, 0
    v_mov_b32 v223, 0
    v_mov_b32 v224, 0
    v_mov_b32 v225, 0
    v_mov_b32 v226, 0
    v_mov_b32 v227, 0
    v_mov_b32 v228, 0
    v_mov_b32 v229, 0
    v_mov_b32 v230, 0
    v_mov_b32 v231, 0
    v_mov_b32 v232, 0
    v_mov_b32 v233, 0
    v_mov_b32 v234, 0
    v_mov_b32 v235, 0
    v_mov_b32 v236, 0
    v_mov_b32 v237, 0
    v_mov_b32 v238, 0
    v_mov_b32 v239, 0
    v_mov_b32 v240, 0
    v_mov_b32 v241, 0
    v_mov_b32 v242, 0
    v_mov_b32 v243, 0
    v_mov_b32 v244, 0
    v_mov_b32 v245, 0
    v_mov_b32 v246, 0
    v_mov_b32 v247, 0
    v_mov_b32 v248, 0
    v_mov_b32 v249, 0
    v_mov_b32 v250, 0
    v_mov_b32 v251, 0
    v_mov_b32 v252, 0
    v_mov_b32 v253, 0
    v_mov_b32 v254, 0
    v_mov_b32 v255, 0
    s_waitcnt lgkmcnt(0)
    s_cmp_ge_u32 s18, 4
    s_cbranch_scc1 K1_V_START
    s_barrier
    ds_read_b64_tr_b16 v[4:5], v44 offset:0
    ds_read_b64_tr_b16 v[6:7], v44 offset:2560
    ds_read_b128 v[24:27], v40 offset:0
    ds_read_b128 v[28:31], v40 offset:4096
    ds_read_b64_tr_b16 v[8:9], v45 offset:64
    ds_read_b64_tr_b16 v[10:11], v45 offset:2624
    ds_read_b64_tr_b16 v[12:13], v44 offset:128
    ds_read_b64_tr_b16 v[14:15], v44 offset:2688
    ds_read_b64_tr_b16 v[16:17], v45 offset:192
    ds_read_b64_tr_b16 v[18:19], v45 offset:2752
    ds_read_b64_tr_b16 v[20:21], v44 offset:256
    ds_read_b64_tr_b16 v[22:23], v44 offset:2816
    s_mov_b32 s26, 0
    s_mov_b32 s22, s44
    s_mov_b32 s23, 1
K1_QK_LOOP:
    s_waitcnt lgkmcnt(8)
    v_mfma_f32_16x16x32_bf16 v[64:67], v[48:51], v[4:7], v[64:67]
    v_mfma_f32_32x32x16_bf16 v[96:111], v[4:7], v[24:27], v[96:111]
    s_add_u32 s25, s25, 1
    s_cmp_eq_u32 s25, 3
    s_cselect_b32 s24, s47, s46
    v_mfma_f32_32x32x16_bf16 v[176:191], v[4:7], v[28:31], v[176:191]
    ds_read_b64_tr_b16 v[4:5], v46 offset:0
    ds_read_b64_tr_b16 v[6:7], v46 offset:2560
    s_waitcnt lgkmcnt(8)
    v_mfma_f32_32x32x16_bf16 v[112:127], v[8:11], v[24:27], v[112:127]
    ds_read_b128 v[32:35], v41 offset:0
    ds_read_b128 v[36:39], v41 offset:4096
    v_mfma_f32_32x32x16_bf16 v[192:207], v[8:11], v[28:31], v[192:207]
    ds_read_b64_tr_b16 v[8:9], v47 offset:64
    ds_read_b64_tr_b16 v[10:11], v47 offset:2624
    s_waitcnt lgkmcnt(10)
    v_mfma_f32_16x16x32_bf16 v[72:75], v[48:51], v[12:15], v[72:75]
    v_mfma_f32_32x32x16_bf16 v[128:143], v[12:15], v[24:27], v[128:143]
    v_add_u32 v44, s22, v44
    v_add_u32 v45, s22, v45
    v_mfma_f32_32x32x16_bf16 v[208:223], v[12:15], v[28:31], v[208:223]
    ds_read_b64_tr_b16 v[12:13], v46 offset:128
    ds_read_b64_tr_b16 v[14:15], v46 offset:2688
    s_waitcnt lgkmcnt(10)
    v_mfma_f32_32x32x16_bf16 v[144:159], v[16:19], v[24:27], v[144:159]
    v_mfma_f32_32x32x16_bf16 v[224:239], v[16:19], v[28:31], v[224:239]
    ds_read_b64_tr_b16 v[16:17], v47 offset:192
    ds_read_b64_tr_b16 v[18:19], v47 offset:2752
    s_waitcnt lgkmcnt(10)
    v_mfma_f32_16x16x32_bf16 v[80:83], v[48:51], v[20:23], v[80:83]
    v_mfma_f32_32x32x16_bf16 v[160:175], v[20:23], v[24:27], v[160:175]
    s_cmp_eq_u32 s25, 3
    s_cselect_b32 s25, 0, s25
    v_mfma_f32_32x32x16_bf16 v[240:255], v[20:23], v[28:31], v[240:255]
    ds_read_b64_tr_b16 v[20:21], v46 offset:256
    ds_read_b64_tr_b16 v[22:23], v46 offset:2816
    s_waitcnt lgkmcnt(8)
    v_mfma_f32_32x32x16_bf16 v[96:111], v[4:7], v[32:35], v[96:111]
    s_barrier
    v_mfma_f32_32x32x16_bf16 v[176:191], v[4:7], v[36:39], v[176:191]
    ds_read_b64_tr_b16 v[4:5], v44 offset:0
    ds_read_b64_tr_b16 v[6:7], v44 offset:2560
    s_waitcnt lgkmcnt(8)
    v_mfma_f32_16x16x32_bf16 v[68:71], v[48:51], v[8:11], v[68:71]
    v_mfma_f32_32x32x16_bf16 v[112:127], v[8:11], v[32:35], v[112:127]
    ds_read_b128 v[24:27], v42 offset:0
    ds_read_b128 v[28:31], v42 offset:4096
    v_mfma_f32_32x32x16_bf16 v[192:207], v[8:11], v[36:39], v[192:207]
    ds_read_b64_tr_b16 v[8:9], v45 offset:64
    ds_read_b64_tr_b16 v[10:11], v45 offset:2624
    s_waitcnt lgkmcnt(10)
    v_mfma_f32_32x32x16_bf16 v[128:143], v[12:15], v[32:35], v[128:143]
    v_add_u32 v46, s22, v46
    v_add_u32 v47, s22, v47
    v_mfma_f32_32x32x16_bf16 v[208:223], v[12:15], v[36:39], v[208:223]
    ds_read_b64_tr_b16 v[12:13], v44 offset:128
    ds_read_b64_tr_b16 v[14:15], v44 offset:2688
    s_waitcnt lgkmcnt(10)
    v_mfma_f32_16x16x32_bf16 v[76:79], v[48:51], v[16:19], v[76:79]
    v_mfma_f32_32x32x16_bf16 v[144:159], v[16:19], v[32:35], v[144:159]
    v_add_u32 v40, s24, v40
    v_add_u32 v41, s24, v41
    s_add_u32 s23, s23, 1
    s_cmp_eq_u32 s23, 5
    v_mfma_f32_32x32x16_bf16 v[224:239], v[16:19], v[36:39], v[224:239]
    ds_read_b64_tr_b16 v[16:17], v45 offset:192
    ds_read_b64_tr_b16 v[18:19], v45 offset:2752
    s_waitcnt lgkmcnt(10)
    v_mfma_f32_32x32x16_bf16 v[160:175], v[20:23], v[32:35], v[160:175]
    s_cselect_b32 s22, s45, s44
    s_cselect_b32 s23, 0, s23
    v_mfma_f32_32x32x16_bf16 v[240:255], v[20:23], v[36:39], v[240:255]
    ds_read_b64_tr_b16 v[20:21], v44 offset:256
    ds_read_b64_tr_b16 v[22:23], v44 offset:2816
    s_waitcnt lgkmcnt(8)
    v_mfma_f32_16x16x32_bf16 v[64:67], v[48:51], v[4:7], v[64:67]
    v_mfma_f32_32x32x16_bf16 v[96:111], v[4:7], v[24:27], v[96:111]
    v_mfma_f32_32x32x16_bf16 v[176:191], v[4:7], v[28:31], v[176:191]
    ds_read_b64_tr_b16 v[4:5], v46 offset:0
    ds_read_b64_tr_b16 v[6:7], v46 offset:2560
    s_waitcnt lgkmcnt(8)
    v_mfma_f32_32x32x16_bf16 v[112:127], v[8:11], v[24:27], v[112:127]
    ds_read_b128 v[32:35], v43 offset:0
    ds_read_b128 v[36:39], v43 offset:4096
    v_mfma_f32_32x32x16_bf16 v[192:207], v[8:11], v[28:31], v[192:207]
    ds_read_b64_tr_b16 v[8:9], v47 offset:64
    ds_read_b64_tr_b16 v[10:11], v47 offset:2624
    s_waitcnt lgkmcnt(10)
    v_mfma_f32_16x16x32_bf16 v[72:75], v[48:51], v[12:15], v[72:75]
    v_mfma_f32_32x32x16_bf16 v[128:143], v[12:15], v[24:27], v[128:143]
    v_add_u32 v44, s22, v44
    v_add_u32 v45, s22, v45
    v_mfma_f32_32x32x16_bf16 v[208:223], v[12:15], v[28:31], v[208:223]
    ds_read_b64_tr_b16 v[12:13], v46 offset:128
    ds_read_b64_tr_b16 v[14:15], v46 offset:2688
    s_waitcnt lgkmcnt(10)
    v_mfma_f32_32x32x16_bf16 v[144:159], v[16:19], v[24:27], v[144:159]
    v_add_u32 v42, s24, v42
    v_mfma_f32_32x32x16_bf16 v[224:239], v[16:19], v[28:31], v[224:239]
    ds_read_b64_tr_b16 v[16:17], v47 offset:192
    ds_read_b64_tr_b16 v[18:19], v47 offset:2752
    s_waitcnt lgkmcnt(10)
    v_mfma_f32_16x16x32_bf16 v[80:83], v[48:51], v[20:23], v[80:83]
    v_mfma_f32_32x32x16_bf16 v[160:175], v[20:23], v[24:27], v[160:175]
    s_add_u32 s26, s26, 1
    v_mfma_f32_32x32x16_bf16 v[240:255], v[20:23], v[28:31], v[240:255]
    ds_read_b64_tr_b16 v[20:21], v46 offset:256
    ds_read_b64_tr_b16 v[22:23], v46 offset:2816
    s_waitcnt lgkmcnt(8)
    v_mfma_f32_32x32x16_bf16 v[96:111], v[4:7], v[32:35], v[96:111]
    s_barrier
    v_mfma_f32_32x32x16_bf16 v[176:191], v[4:7], v[36:39], v[176:191]
    ds_read_b64_tr_b16 v[4:5], v44 offset:0
    ds_read_b64_tr_b16 v[6:7], v44 offset:2560
    s_waitcnt lgkmcnt(8)
    v_mfma_f32_16x16x32_bf16 v[68:71], v[48:51], v[8:11], v[68:71]
    v_mfma_f32_32x32x16_bf16 v[112:127], v[8:11], v[32:35], v[112:127]
    ds_read_b128 v[24:27], v40 offset:0
    ds_read_b128 v[28:31], v40 offset:4096
    v_mfma_f32_32x32x16_bf16 v[192:207], v[8:11], v[36:39], v[192:207]
    ds_read_b64_tr_b16 v[8:9], v45 offset:64
    ds_read_b64_tr_b16 v[10:11], v45 offset:2624
    s_waitcnt lgkmcnt(10)
    v_mfma_f32_32x32x16_bf16 v[128:143], v[12:15], v[32:35], v[128:143]
    v_add_u32 v46, s22, v46
    v_add_u32 v47, s22, v47
    v_mfma_f32_32x32x16_bf16 v[208:223], v[12:15], v[36:39], v[208:223]
    ds_read_b64_tr_b16 v[12:13], v44 offset:128
    ds_read_b64_tr_b16 v[14:15], v44 offset:2688
    s_waitcnt lgkmcnt(10)
    v_mfma_f32_16x16x32_bf16 v[76:79], v[48:51], v[16:19], v[76:79]
    v_mfma_f32_32x32x16_bf16 v[144:159], v[16:19], v[32:35], v[144:159]
    v_add_u32 v43, s24, v43
    s_add_u32 s23, s23, 1
    s_cmp_eq_u32 s23, 5
    v_mfma_f32_32x32x16_bf16 v[224:239], v[16:19], v[36:39], v[224:239]
    ds_read_b64_tr_b16 v[16:17], v45 offset:192
    ds_read_b64_tr_b16 v[18:19], v45 offset:2752
    s_waitcnt lgkmcnt(10)
    v_mfma_f32_32x32x16_bf16 v[160:175], v[20:23], v[32:35], v[160:175]
    s_cselect_b32 s22, s45, s44
    s_cselect_b32 s23, 0, s23
    s_cmp_lt_u32 s26, 10
    v_mfma_f32_32x32x16_bf16 v[240:255], v[20:23], v[36:39], v[240:255]
    ds_read_b64_tr_b16 v[20:21], v44 offset:256
    ds_read_b64_tr_b16 v[22:23], v44 offset:2816
    s_cbranch_scc1 K1_QK_LOOP
    s_nop 7
    s_mov_b64 exec, 0xffff
    ds_write_b32 v62, v64 offset:0
    ds_write_b32 v62, v65 offset:64
    ds_write_b32 v62, v68 offset:128
    ds_write_b32 v62, v69 offset:192
    ds_write_b32 v62, v72 offset:256
    ds_write_b32 v62, v73 offset:320
    ds_write_b32 v62, v76 offset:384
    ds_write_b32 v62, v77 offset:448
    ds_write_b32 v62, v80 offset:512
    ds_write_b32 v62, v81 offset:576
    s_mov_b64 exec, -1
    s_waitcnt lgkmcnt(0)
    s_barrier
    ds_read_b64 v[64:65], v63 offset:0
    ds_read_b64 v[66:67], v63 offset:256
    s_barrier
    v_lshrrev_b32 v58, 5, v0
    v_lshlrev_b32 v58, 4, v58
    s_mul_i32 s27, s20, 640
    s_add_u32 s27, s27, 151872
    v_add_u32 v58, s27, v58
    ds_read_b128 v[4:7], v58 offset:0
    ds_read_b128 v[8:11], v58 offset:32
    ds_read_b128 v[12:15], v58 offset:64
    ds_read_b128 v[16:19], v58 offset:96
    s_cmp_lt_u32 s18, 2
    s_cselect_b32 s27, 0, 2621440
    s_add_u32 s4, s34, s27
    s_addc_u32 s5, s35, 0
    s_mov_b32 s6, 2621440
    s_mov_b32 s7, 0x00020000
    s_cmp_lt_u32 s18, 2
    s_cselect_b32 s29, 0x3ea52b5c, 0x3f800000
    s_and_b32 s27, s18, 1
    s_lshl_b32 s27, s27, 4
    s_lshl_b32 s30, s20, 3
    s_add_u32 s27, s27, s30
    s_mul_i32 s30, s27, 81920
    s_lshl_b32 s31, s17, 2
    s_lshl_b32 s27, s19, 1
    s_add_u32 s31, s31, s27
    s_mul_i32 s31, s31, 1280
    s_add_u32 s30, s30, s31
    v_lshlrev_b32 v71, 4, v0
    v_and_b32 v72, 31, v0
    v_lshlrev_b32 v72, 3, v72
    v_lshrrev_b32 v59, 5, v0
    v_mul_u32_u24 v59, 81920, v59
    v_add_u32 v72, v72, v59
    v_add_u32 v72, 1024, v72
    s_waitcnt lgkmcnt(4)
    v_mul_f32 v65, s29, v65
    v_mul_f32 v67, s29, v67
    ds_read_b128 v[20:23], v58 offset:128
    ds_read_b128 v[24:27], v58 offset:160
    ds_read_b128 v[28:31], v58 offset:192
    ds_read_b128 v[32:35], v58 offset:224
    s_waitcnt lgkmcnt(4)
    v_pk_fma_f32 v[76:77], v[4:5], v[64:65], v[96:97] op_sel:[0,0,0] op_sel_hi:[1,0,1]
    v_pk_fma_f32 v[78:79], v[6:7], v[64:65], v[98:99] op_sel:[0,0,0] op_sel_hi:[1,0,1]
    v_pk_mul_f32 v[76:77], v[76:77], v[64:65] op_sel:[0,1] op_sel_hi:[1,1]
    v_pk_mul_f32 v[78:79], v[78:79], v[64:65] op_sel:[0,1] op_sel_hi:[1,1]
    v_pk_fma_f32 v[80:81], v[4:5], v[66:67], v[176:177] op_sel:[0,0,0] op_sel_hi:[1,0,1]
    v_pk_fma_f32 v[82:83], v[6:7], v[66:67], v[178:179] op_sel:[0,0,0] op_sel_hi:[1,0,1]
    v_pk_mul_f32 v[80:81], v[80:81], v[66:67] op_sel:[0,1] op_sel_hi:[1,1]
    v_pk_mul_f32 v[82:83], v[82:83], v[66:67] op_sel:[0,1] op_sel_hi:[1,1]
    v_cvt_pk_bf16_f32 v96, v76, v77
    v_cvt_pk_bf16_f32 v97, v78, v79
    v_cvt_pk_bf16_f32 v176, v80, v81
    v_cvt_pk_bf16_f32 v177, v82, v83
    v_pk_fma_f32 v[76:77], v[8:9], v[64:65], v[100:101] op_sel:[0,0,0] op_sel_hi:[1,0,1]
    v_pk_fma_f32 v[78:79], v[10:11], v[64:65], v[102:103] op_sel:[0,0,0] op_sel_hi:[1,0,1]
    v_pk_mul_f32 v[76:77], v[76:77], v[64:65] op_sel:[0,1] op_sel_hi:[1,1]
    v_pk_mul_f32 v[78:79], v[78:79], v[64:65] op_sel:[0,1] op_sel_hi:[1,1]
    v_pk_fma_f32 v[80:81], v[8:9], v[66:67], v[180:181] op_sel:[0,0,0] op_sel_hi:[1,0,1]
    v_pk_fma_f32 v[82:83], v[10:11], v[66:67], v[182:183] op_sel:[0,0,0] op_sel_hi:[1,0,1]
    v_pk_mul_f32 v[80:81], v[80:81], v[66:67] op_sel:[0,1] op_sel_hi:[1,1]
    v_pk_mul_f32 v[82:83], v[82:83], v[66:67] op_sel:[0,1] op_sel_hi:[1,1]
    v_cvt_pk_bf16_f32 v98, v76, v77
    v_cvt_pk_bf16_f32 v99, v78, v79
    v_cvt_pk_bf16_f32 v178, v80, v81
    v_cvt_pk_bf16_f32 v179, v82, v83
    v_pk_fma_f32 v[76:77], v[12:13], v[64:65], v[104:105] op_sel:[0,0,0] op_sel_hi:[1,0,1]
    v_pk_fma_f32 v[78:79], v[14:15], v[64:65], v[106:107] op_sel:[0,0,0] op_sel_hi:[1,0,1]
    v_pk_mul_f32 v[76:77], v[76:77], v[64:65] op_sel:[0,1] op_sel_hi:[1,1]
    v_pk_mul_f32 v[78:79], v[78:79], v[64:65] op_sel:[0,1] op_sel_hi:[1,1]
    v_pk_fma_f32 v[80:81], v[12:13], v[66:67], v[184:185] op_sel:[0,0,0] op_sel_hi:[1,0,1]
    v_pk_fma_f32 v[82:83], v[14:15], v[66:67], v[186:187] op_sel:[0,0,0] op_sel_hi:[1,0,1]
    v_pk_mul_f32 v[80:81], v[80:81], v[66:67] op_sel:[0,1] op_sel_hi:[1,1]
    v_pk_mul_f32 v[82:83], v[82:83], v[66:67] op_sel:[0,1] op_sel_hi:[1,1]
    v_cvt_pk_bf16_f32 v100, v76, v77
    v_cvt_pk_bf16_f32 v101, v78, v79
    v_cvt_pk_bf16_f32 v180, v80, v81
    v_cvt_pk_bf16_f32 v181, v82, v83
    v_pk_fma_f32 v[76:77], v[16:17], v[64:65], v[108:109] op_sel:[0,0,0] op_sel_hi:[1,0,1]
    v_pk_fma_f32 v[78:79], v[18:19], v[64:65], v[110:111] op_sel:[0,0,0] op_sel_hi:[1,0,1]
    v_pk_mul_f32 v[76:77], v[76:77], v[64:65] op_sel:[0,1] op_sel_hi:[1,1]
    v_pk_mul_f32 v[78:79], v[78:79], v[64:65] op_sel:[0,1] op_sel_hi:[1,1]
    v_pk_fma_f32 v[80:81], v[16:17], v[66:67], v[188:189] op_sel:[0,0,0] op_sel_hi:[1,0,1]
    v_pk_fma_f32 v[82:83], v[18:19], v[66:67], v[190:191] op_sel:[0,0,0] op_sel_hi:[1,0,1]
    v_pk_mul_f32 v[80:81], v[80:81], v[66:67] op_sel:[0,1] op_sel_hi:[1,1]
    v_pk_mul_f32 v[82:83], v[82:83], v[66:67] op_sel:[0,1] op_sel_hi:[1,1]
    v_cvt_pk_bf16_f32 v104, v76, v77
    v_cvt_pk_bf16_f32 v105, v78, v79
    v_cvt_pk_bf16_f32 v184, v80, v81
    v_cvt_pk_bf16_f32 v185, v82, v83
    ds_read_b128 v[4:7], v58 offset:256
    ds_read_b128 v[8:11], v58 offset:288
    ds_read_b128 v[12:15], v58 offset:320
    ds_read_b128 v[16:19], v58 offset:352
    s_waitcnt lgkmcnt(4)
    v_pk_fma_f32 v[76:77], v[20:21], v[64:65], v[112:113] op_sel:[0,0,0] op_sel_hi:[1,0,1]
    v_pk_fma_f32 v[78:79], v[22:23], v[64:65], v[114:115] op_sel:[0,0,0] op_sel_hi:[1,0,1]
    v_pk_mul_f32 v[76:77], v[76:77], v[64:65] op_sel:[0,1] op_sel_hi:[1,1]
    v_pk_mul_f32 v[78:79], v[78:79], v[64:65] op_sel:[0,1] op_sel_hi:[1,1]
    v_pk_fma_f32 v[80:81], v[20:21], v[66:67], v[192:193] op_sel:[0,0,0] op_sel_hi:[1,0,1]
    v_pk_fma_f32 v[82:83], v[22:23], v[66:67], v[194:195] op_sel:[0,0,0] op_sel_hi:[1,0,1]
    v_pk_mul_f32 v[80:81], v[80:81], v[66:67] op_sel:[0,1] op_sel_hi:[1,1]
    v_pk_mul_f32 v[82:83], v[82:83], v[66:67] op_sel:[0,1] op_sel_hi:[1,1]
    v_cvt_pk_bf16_f32 v106, v76, v77
    v_cvt_pk_bf16_f32 v107, v78, v79
    v_cvt_pk_bf16_f32 v186, v80, v81
    v_cvt_pk_bf16_f32 v187, v82, v83
    s_add_u32 s27, s30, 0
    s_add_u32 s31, s27, 81920
    buffer_store_dwordx4 v[96:99], v71, s[4:7], s27 offen sc1
    buffer_store_dwordx4 v[104:107], v71, s[4:7], s31 offen sc1
    buffer_store_dwordx2 v[100:101], v72, s[4:7], s27 offen sc1
    s_add_u32 s27, s30, 1280
    s_add_u32 s31, s27, 81920
    buffer_store_dwordx4 v[176:179], v71, s[4:7], s27 offen sc1
    buffer_store_dwordx4 v[184:187], v71, s[4:7], s31 offen sc1
    buffer_store_dwordx2 v[180:181], v72, s[4:7], s27 offen sc1
    v_pk_fma_f32 v[76:77], v[24:25], v[64:65], v[116:117] op_sel:[0,0,0] op_sel_hi:[1,0,1]
    v_pk_fma_f32 v[78:79], v[26:27], v[64:65], v[118:119] op_sel:[0,0,0] op_sel_hi:[1,0,1]
    v_pk_mul_f32 v[76:77], v[76:77], v[64:65] op_sel:[0,1] op_sel_hi:[1,1]
    v_pk_mul_f32 v[78:79], v[78:79], v[64:65] op_sel:[0,1] op_sel_hi:[1,1]
    v_pk_fma_f32 v[80:81], v[24:25], v[66:67], v[196:197] op_sel:[0,0,0] op_sel_hi:[1,0,1]
    v_pk_fma_f32 v[82:83], v[26:27], v[66:67], v[198:199] op_sel:[0,0,0] op_sel_hi:[1,0,1]
    v_pk_mul_f32 v[80:81], v[80:81], v[66:67] op_sel:[0,1] op_sel_hi:[1,1]
    v_pk_mul_f32 v[82:83], v[82:83], v[66:67] op_sel:[0,1] op_sel_hi:[1,1]
    v_cvt_pk_bf16_f32 v116, v76, v77
    v_cvt_pk_bf16_f32 v117, v78, v79
    v_cvt_pk_bf16_f32 v196, v80, v81
    v_cvt_pk_bf16_f32 v197, v82, v83
    v_pk_fma_f32 v[76:77], v[28:29], v[64:65], v[120:121] op_sel:[0,0,0] op_sel_hi:[1,0,1]
    v_pk_fma_f32 v[78:79], v[30:31], v[64:65], v[122:123] op_sel:[0,0,0] op_sel_hi:[1,0,1]
    v_pk_mul_f32 v[76:77], v[76:77], v[64:65] op_sel:[0,1] op_sel_hi:[1,1]
    v_pk_mul_f32 v[78:79], v[78:79], v[64:65] op_sel:[0,1] op_sel_hi:[1,1]
    v_pk_fma_f32 v[80:81], v[28:29], v[66:67], v[200:201] op_sel:[0,0,0] op_sel_hi:[1,0,1]
    v_pk_fma_f32 v[82:83], v[30:31], v[66:67], v[202:203] op_sel:[0,0,0] op_sel_hi:[1,0,1]
    v_pk_mul_f32 v[80:81], v[80:81], v[66:67] op_sel:[0,1] op_sel_hi:[1,1]
    v_pk_mul_f32 v[82:83], v[82:83], v[66:67] op_sel:[0,1] op_sel_hi:[1,1]
    v_cvt_pk_bf16_f32 v118, v76, v77
    v_cvt_pk_bf16_f32 v119, v78, v79
    v_cvt_pk_bf16_f32 v198, v80, v81
    v_cvt_pk_bf16_f32 v199, v82, v83
    v_pk_fma_f32 v[76:77], v[32:33], v[64:65], v[124:125] op_sel:[0,0,0] op_sel_hi:[1,0,1]
    v_pk_fma_f32 v[78:79], v[34:35], v[64:65], v[126:127] op_sel:[0,0,0] op_sel_hi:[1,0,1]
    v_pk_mul_f32 v[76:77], v[76:77], v[64:65] op_sel:[0,1] op_sel_hi:[1,1]
    v_pk_mul_f32 v[78:79], v[78:79], v[64:65] op_sel:[0,1] op_sel_hi:[1,1]
    v_pk_fma_f32 v[80:81], v[32:33], v[66:67], v[204:205] op_sel:[0,0,0] op_sel_hi:[1,0,1]
    v_pk_fma_f32 v[82:83], v[34:35], v[66:67], v[206:207] op_sel:[0,0,0] op_sel_hi:[1,0,1]
    v_pk_mul_f32 v[80:81], v[80:81], v[66:67] op_sel:[0,1] op_sel_hi:[1,1]
    v_pk_mul_f32 v[82:83], v[82:83], v[66:67] op_sel:[0,1] op_sel_hi:[1,1]
    v_cvt_pk_bf16_f32 v120, v76, v77
    v_cvt_pk_bf16_f32 v121, v78, v79
    v_cvt_pk_bf16_f32 v200, v80, v81
    v_cvt_pk_bf16_f32 v201, v82, v83
    ds_read_b128 v[20:23], v58 offset:384
    ds_read_b128 v[24:27], v58 offset:416
    ds_read_b128 v[28:31], v58 offset:448
    ds_read_b128 v[32:35], v58 offset:480
    s_waitcnt lgkmcnt(4)
    v_pk_fma_f32 v[76:77], v[4:5], v[64:65], v[128:129] op_sel:[0,0,0] op_sel_hi:[1,0,1]
    v_pk_fma_f32 v[78:79], v[6:7], v[64:65], v[130:131] op_sel:[0,0,0] op_sel_hi:[1,0,1]
    v_pk_mul_f32 v[76:77], v[76:77], v[64:65] op_sel:[0,1] op_sel_hi:[1,1]
    v_pk_mul_f32 v[78:79], v[78:79], v[64:65] op_sel:[0,1] op_sel_hi:[1,1]
    v_pk_fma_f32 v[80:81], v[4:5], v[66:67], v[208:209] op_sel:[0,0,0] op_sel_hi:[1,0,1]
    v_pk_fma_f32 v[82:83], v[6:7], v[66:67], v[210:211] op_sel:[0,0,0] op_sel_hi:[1,0,1]
    v_pk_mul_f32 v[80:81], v[80:81], v[66:67] op_sel:[0,1] op_sel_hi:[1,1]
    v_pk_mul_f32 v[82:83], v[82:83], v[66:67] op_sel:[0,1] op_sel_hi:[1,1]
    v_cvt_pk_bf16_f32 v124, v76, v77
    v_cvt_pk_bf16_f32 v125, v78, v79
    v_cvt_pk_bf16_f32 v204, v80, v81
    v_cvt_pk_bf16_f32 v205, v82, v83
    v_pk_fma_f32 v[76:77], v[8:9], v[64:65], v[132:133] op_sel:[0,0,0] op_sel_hi:[1,0,1]
    v_pk_fma_f32 v[78:79], v[10:11], v[64:65], v[134:135] op_sel:[0,0,0] op_sel_hi:[1,0,1]
    v_pk_mul_f32 v[76:77], v[76:77], v[64:65] op_sel:[0,1] op_sel_hi:[1,1]
    v_pk_mul_f32 v[78:79], v[78:79], v[64:65] op_sel:[0,1] op_sel_hi:[1,1]
    v_pk_fma_f32 v[80:81], v[8:9], v[66:67], v[212:213] op_sel:[0,0,0] op_sel_hi:[1,0,1]
    v_pk_fma_f32 v[82:83], v[10:11], v[66:67], v[214:215] op_sel:[0,0,0] op_sel_hi:[1,0,1]
    v_pk_mul_f32 v[80:81], v[80:81], v[66:67] op_sel:[0,1] op_sel_hi:[1,1]
    v_pk_mul_f32 v[82:83], v[82:83], v[66:67] op_sel:[0,1] op_sel_hi:[1,1]
    v_cvt_pk_bf16_f32 v126, v76, v77
    v_cvt_pk_bf16_f32 v127, v78, v79
    v_cvt_pk_bf16_f32 v206, v80, v81
    v_cvt_pk_bf16_f32 v207, v82, v83
    s_add_u32 s27, s30, 163840
    s_add_u32 s31, s27, 81920
    buffer_store_dwordx4 v[116:119], v71, s[4:7], s27 offen sc1
    buffer_store_dwordx4 v[124:127], v71, s[4:7], s31 offen sc1
    buffer_store_dwordx2 v[120:121], v72, s[4:7], s27 offen sc1
    s_add_u32 s27, s30, 165120
    s_add_u32 s31, s27, 81920
    buffer_store_dwordx4 v[196:199], v71, s[4:7], s27 offen sc1
    buffer_store_dwordx4 v[204:207], v71, s[4:7], s31 offen sc1
    buffer_store_dwordx2 v[200:201], v72, s[4:7], s27 offen sc1
    v_pk_fma_f32 v[76:77], v[12:13], v[64:65], v[136:137] op_sel:[0,0,0] op_sel_hi:[1,0,1]
    v_pk_fma_f32 v[78:79], v[14:15], v[64:65], v[138:139] op_sel:[0,0,0] op_sel_hi:[1,0,1]
    v_pk_mul_f32 v[76:77], v[76:77], v[64:65] op_sel:[0,1] op_sel_hi:[1,1]
    v_pk_mul_f32 v[78:79], v[78:79], v[64:65] op_sel:[0,1] op_sel_hi:[1,1]
    v_pk_fma_f32 v[80:81], v[12:13], v[66:67], v[216:217] op_sel:[0,0,0] op_sel_hi:[1,0,1]
    v_pk_fma_f32 v[82:83], v[14:15], v[66:67], v[218:219] op_sel:[0,0,0] op_sel_hi:[1,0,1]
    v_pk_mul_f32 v[80:81], v[80:81], v[66:67] op_sel:[0,1] op_sel_hi:[1,1]
    v_pk_mul_f32 v[82:83], v[82:83], v[66:67] op_sel:[0,1] op_sel_hi:[1,1]
    v_cvt_pk_bf16_f32 v136, v76, v77
    v_cvt_pk_bf16_f32 v137, v78, v79
    v_cvt_pk_bf16_f32 v216, v80, v81
    v_cvt_pk_bf16_f32 v217, v82, v83
    v_pk_fma_f32 v[76:77], v[16:17], v[64:65], v[140:141] op_sel:[0,0,0] op_sel_hi:[1,0,1]
    v_pk_fma_f32 v[78:79], v[18:19], v[64:65], v[142:143] op_sel:[0,0,0] op_sel_hi:[1,0,1]
    v_pk_mul_f32 v[76:77], v[76:77], v[64:65] op_sel:[0,1] op_sel_hi:[1,1]
    v_pk_mul_f32 v[78:79], v[78:79], v[64:65] op_sel:[0,1] op_sel_hi:[1,1]
    v_pk_fma_f32 v[80:81], v[16:17], v[66:67], v[220:221] op_sel:[0,0,0] op_sel_hi:[1,0,1]
    v_pk_fma_f32 v[82:83], v[18:19], v[66:67], v[222:223] op_sel:[0,0,0] op_sel_hi:[1,0,1]
    v_pk_mul_f32 v[80:81], v[80:81], v[66:67] op_sel:[0,1] op_sel_hi:[1,1]
    v_pk_mul_f32 v[82:83], v[82:83], v[66:67] op_sel:[0,1] op_sel_hi:[1,1]
    v_cvt_pk_bf16_f32 v138, v76, v77
    v_cvt_pk_bf16_f32 v139, v78, v79
    v_cvt_pk_bf16_f32 v218, v80, v81
    v_cvt_pk_bf16_f32 v219, v82, v83
    ds_read_b128 v[4:7], v58 offset:512
    ds_read_b128 v[8:11], v58 offset:544
    ds_read_b128 v[12:15], v58 offset:576
    ds_read_b128 v[16:19], v58 offset:608
    s_waitcnt lgkmcnt(4)
    v_pk_fma_f32 v[76:77], v[20:21], v[64:65], v[144:145] op_sel:[0,0,0] op_sel_hi:[1,0,1]
    v_pk_fma_f32 v[78:79], v[22:23], v[64:65], v[146:147] op_sel:[0,0,0] op_sel_hi:[1,0,1]
    v_pk_mul_f32 v[76:77], v[76:77], v[64:65] op_sel:[0,1] op_sel_hi:[1,1]
    v_pk_mul_f32 v[78:79], v[78:79], v[64:65] op_sel:[0,1] op_sel_hi:[1,1]
    v_pk_fma_f32 v[80:81], v[20:21], v[66:67], v[224:225] op_sel:[0,0,0] op_sel_hi:[1,0,1]
    v_pk_fma_f32 v[82:83], v[22:23], v[66:67], v[226:227] op_sel:[0,0,0] op_sel_hi:[1,0,1]
    v_pk_mul_f32 v[80:81], v[80:81], v[66:67] op_sel:[0,1] op_sel_hi:[1,1]
    v_pk_mul_f32 v[82:83], v[82:83], v[66:67] op_sel:[0,1] op_sel_hi:[1,1]
    v_cvt_pk_bf16_f32 v140, v76, v77
    v_cvt_pk_bf16_f32 v141, v78, v79
    v_cvt_pk_bf16_f32 v220, v80, v81
    v_cvt_pk_bf16_f32 v221, v82, v83
    v_pk_fma_f32 v[76:77], v[24:25], v[64:65], v[148:149] op_sel:[0,0,0] op_sel_hi:[1,0,1]
    v_pk_fma_f32 v[78:79], v[26:27], v[64:65], v[150:151] op_sel:[0,0,0] op_sel_hi:[1,0,1]
    v_pk_mul_f32 v[76:77], v[76:77], v[64:65] op_sel:[0,1] op_sel_hi:[1,1]
    v_pk_mul_f32 v[78:79], v[78:79], v[64:65] op_sel:[0,1] op_sel_hi:[1,1]
    v_pk_fma_f32 v[80:81], v[24:25], v[66:67], v[228:229] op_sel:[0,0,0] op_sel_hi:[1,0,1]
    v_pk_fma_f32 v[82:83], v[26:27], v[66:67], v[230:231] op_sel:[0,0,0] op_sel_hi:[1,0,1]
    v_pk_mul_f32 v[80:81], v[80:81], v[66:67] op_sel:[0,1] op_sel_hi:[1,1]
    v_pk_mul_f32 v[82:83], v[82:83], v[66:67] op_sel:[0,1] op_sel_hi:[1,1]
    v_cvt_pk_bf16_f32 v144, v76, v77
    v_cvt_pk_bf16_f32 v145, v78, v79
    v_cvt_pk_bf16_f32 v224, v80, v81
    v_cvt_pk_bf16_f32 v225, v82, v83
    v_pk_fma_f32 v[76:77], v[28:29], v[64:65], v[152:153] op_sel:[0,0,0] op_sel_hi:[1,0,1]
    v_pk_fma_f32 v[78:79], v[30:31], v[64:65], v[154:155] op_sel:[0,0,0] op_sel_hi:[1,0,1]
    v_pk_mul_f32 v[76:77], v[76:77], v[64:65] op_sel:[0,1] op_sel_hi:[1,1]
    v_pk_mul_f32 v[78:79], v[78:79], v[64:65] op_sel:[0,1] op_sel_hi:[1,1]
    v_pk_fma_f32 v[80:81], v[28:29], v[66:67], v[232:233] op_sel:[0,0,0] op_sel_hi:[1,0,1]
    v_pk_fma_f32 v[82:83], v[30:31], v[66:67], v[234:235] op_sel:[0,0,0] op_sel_hi:[1,0,1]
    v_pk_mul_f32 v[80:81], v[80:81], v[66:67] op_sel:[0,1] op_sel_hi:[1,1]
    v_pk_mul_f32 v[82:83], v[82:83], v[66:67] op_sel:[0,1] op_sel_hi:[1,1]
    v_cvt_pk_bf16_f32 v146, v76, v77
    v_cvt_pk_bf16_f32 v147, v78, v79
    v_cvt_pk_bf16_f32 v226, v80, v81
    v_cvt_pk_bf16_f32 v227, v82, v83
    s_add_u32 s27, s30, 327680
    s_add_u32 s31, s27, 81920
    buffer_store_dwordx4 v[136:139], v71, s[4:7], s27 offen sc1
    buffer_store_dwordx4 v[144:147], v71, s[4:7], s31 offen sc1
    buffer_store_dwordx2 v[140:141], v72, s[4:7], s27 offen sc1
    s_add_u32 s27, s30, 328960
    s_add_u32 s31, s27, 81920
    buffer_store_dwordx4 v[216:219], v71, s[4:7], s27 offen sc1
    buffer_store_dwordx4 v[224:227], v71, s[4:7], s31 offen sc1
    buffer_store_dwordx2 v[220:221], v72, s[4:7], s27 offen sc1
    v_pk_fma_f32 v[76:77], v[32:33], v[64:65], v[156:157] op_sel:[0,0,0] op_sel_hi:[1,0,1]
    v_pk_fma_f32 v[78:79], v[34:35], v[64:65], v[158:159] op_sel:[0,0,0] op_sel_hi:[1,0,1]
    v_pk_mul_f32 v[76:77], v[76:77], v[64:65] op_sel:[0,1] op_sel_hi:[1,1]
    v_pk_mul_f32 v[78:79], v[78:79], v[64:65] op_sel:[0,1] op_sel_hi:[1,1]
    v_pk_fma_f32 v[80:81], v[32:33], v[66:67], v[236:237] op_sel:[0,0,0] op_sel_hi:[1,0,1]
    v_pk_fma_f32 v[82:83], v[34:35], v[66:67], v[238:239] op_sel:[0,0,0] op_sel_hi:[1,0,1]
    v_pk_mul_f32 v[80:81], v[80:81], v[66:67] op_sel:[0,1] op_sel_hi:[1,1]
    v_pk_mul_f32 v[82:83], v[82:83], v[66:67] op_sel:[0,1] op_sel_hi:[1,1]
    v_cvt_pk_bf16_f32 v156, v76, v77
    v_cvt_pk_bf16_f32 v157, v78, v79
    v_cvt_pk_bf16_f32 v236, v80, v81
    v_cvt_pk_bf16_f32 v237, v82, v83
    s_waitcnt lgkmcnt(0)
    v_pk_fma_f32 v[76:77], v[4:5], v[64:65], v[160:161] op_sel:[0,0,0] op_sel_hi:[1,0,1]
    v_pk_fma_f32 v[78:79], v[6:7], v[64:65], v[162:163] op_sel:[0,0,0] op_sel_hi:[1,0,1]
    v_pk_mul_f32 v[76:77], v[76:77], v[64:65] op_sel:[0,1] op_sel_hi:[1,1]
    v_pk_mul_f32 v[78:79], v[78:79], v[64:65] op_sel:[0,1] op_sel_hi:[1,1]
    v_pk_fma_f32 v[80:81], v[4:5], v[66:67], v[240:241] op_sel:[0,0,0] op_sel_hi:[1,0,1]
    v_pk_fma_f32 v[82:83], v[6:7], v[66:67], v[242:243] op_sel:[0,0,0] op_sel_hi:[1,0,1]
    v_pk_mul_f32 v[80:81], v[80:81], v[66:67] op_sel:[0,1] op_sel_hi:[1,1]
    v_pk_mul_f32 v[82:83], v[82:83], v[66:67] op_sel:[0,1] op_sel_hi:[1,1]
    v_cvt_pk_bf16_f32 v158, v76, v77
    v_cvt_pk_bf16_f32 v159, v78, v79
    v_cvt_pk_bf16_f32 v238, v80, v81
    v_cvt_pk_bf16_f32 v239, v82, v83
    v_pk_fma_f32 v[76:77], v[8:9], v[64:65], v[164:165] op_sel:[0,0,0] op_sel_hi:[1,0,1]
    v_pk_fma_f32 v[78:79], v[10:11], v[64:65], v[166:167] op_sel:[0,0,0] op_sel_hi:[1,0,1]
    v_pk_mul_f32 v[76:77], v[76:77], v[64:65] op_sel:[0,1] op_sel_hi:[1,1]
    v_pk_mul_f32 v[78:79], v[78:79], v[64:65] op_sel:[0,1] op_sel_hi:[1,1]
    v_pk_fma_f32 v[80:81], v[8:9], v[66:67], v[244:245] op_sel:[0,0,0] op_sel_hi:[1,0,1]
    v_pk_fma_f32 v[82:83], v[10:11], v[66:67], v[246:247] op_sel:[0,0,0] op_sel_hi:[1,0,1]
    v_pk_mul_f32 v[80:81], v[80:81], v[66:67] op_sel:[0,1] op_sel_hi:[1,1]
    v_pk_mul_f32 v[82:83], v[82:83], v[66:67] op_sel:[0,1] op_sel_hi:[1,1]
    v_cvt_pk_bf16_f32 v160, v76, v77
    v_cvt_pk_bf16_f32 v161, v78, v79
    v_cvt_pk_bf16_f32 v240, v80, v81
    v_cvt_pk_bf16_f32 v241, v82, v83
    v_pk_fma_f32 v[76:77], v[12:13], v[64:65], v[168:169] op_sel:[0,0,0] op_sel_hi:[1,0,1]
    v_pk_fma_f32 v[78:79], v[14:15], v[64:65], v[170:171] op_sel:[0,0,0] op_sel_hi:[1,0,1]
    v_pk_mul_f32 v[76:77], v[76:77], v[64:65] op_sel:[0,1] op_sel_hi:[1,1]
    v_pk_mul_f32 v[78:79], v[78:79], v[64:65] op_sel:[0,1] op_sel_hi:[1,1]
    v_pk_fma_f32 v[80:81], v[12:13], v[66:67], v[248:249] op_sel:[0,0,0] op_sel_hi:[1,0,1]
    v_pk_fma_f32 v[82:83], v[14:15], v[66:67], v[250:251] op_sel:[0,0,0] op_sel_hi:[1,0,1]
    v_pk_mul_f32 v[80:81], v[80:81], v[66:67] op_sel:[0,1] op_sel_hi:[1,1]
    v_pk_mul_f32 v[82:83], v[82:83], v[66:67] op_sel:[0,1] op_sel_hi:[1,1]
    v_cvt_pk_bf16_f32 v164, v76, v77
    v_cvt_pk_bf16_f32 v165, v78, v79
    v_cvt_pk_bf16_f32 v244, v80, v81
    v_cvt_pk_bf16_f32 v245, v82, v83
    v_pk_fma_f32 v[76:77], v[16:17], v[64:65], v[172:173] op_sel:[0,0,0] op_sel_hi:[1,0,1]
    v_pk_fma_f32 v[78:79], v[18:19], v[64:65], v[174:175] op_sel:[0,0,0] op_sel_hi:[1,0,1]
    v_pk_mul_f32 v[76:77], v[76:77], v[64:65] op_sel:[0,1] op_sel_hi:[1,1]
    v_pk_mul_f32 v[78:79], v[78:79], v[64:65] op_sel:[0,1] op_sel_hi:[1,1]
    v_pk_fma_f32 v[80:81], v[16:17], v[66:67], v[252:253] op_sel:[0,0,0] op_sel_hi:[1,0,1]
    v_pk_fma_f32 v[82:83], v[18:19], v[66:67], v[254:255] op_sel:[0,0,0] op_sel_hi:[1,0,1]
    v_pk_mul_f32 v[80:81], v[80:81], v[66:67] op_sel:[0,1] op_sel_hi:[1,1]
    v_pk_mul_f32 v[82:83], v[82:83], v[66:67] op_sel:[0,1] op_sel_hi:[1,1]
    v_cvt_pk_bf16_f32 v166, v76, v77
    v_cvt_pk_bf16_f32 v167, v78, v79
    v_cvt_pk_bf16_f32 v246, v80, v81
    v_cvt_pk_bf16_f32 v247, v82, v83
    s_add_u32 s27, s30, 491520
    s_add_u32 s31, s27, 81920
    buffer_store_dwordx4 v[156:159], v71, s[4:7], s27 offen sc1
    buffer_store_dwordx4 v[164:167], v71, s[4:7], s31 offen sc1
    buffer_store_dwordx2 v[160:161], v72, s[4:7], s27 offen sc1
    s_add_u32 s27, s30, 492800
    s_add_u32 s31, s27, 81920
    buffer_store_dwordx4 v[236:239], v71, s[4:7], s27 offen sc1
    buffer_store_dwordx4 v[244:247], v71, s[4:7], s31 offen sc1
    buffer_store_dwordx2 v[240:241], v72, s[4:7], s27 offen sc1
    s_branch K1_DONE
K1_V_START:
    s_barrier
    ds_read_b64_tr_b16 v[4:5], v44 offset:0
    ds_read_b64_tr_b16 v[6:7], v44 offset:2560
    ds_read_b128 v[24:27], v40 offset:0
    ds_read_b128 v[28:31], v40 offset:4096
    ds_read_b64_tr_b16 v[8:9], v45 offset:64
    ds_read_b64_tr_b16 v[10:11], v45 offset:2624
    ds_read_b64_tr_b16 v[12:13], v44 offset:128
    ds_read_b64_tr_b16 v[14:15], v44 offset:2688
    ds_read_b64_tr_b16 v[16:17], v45 offset:192
    ds_read_b64_tr_b16 v[18:19], v45 offset:2752
    ds_read_b64_tr_b16 v[20:21], v44 offset:256
    ds_read_b64_tr_b16 v[22:23], v44 offset:2816
    s_mov_b32 s26, 0
    s_mov_b32 s22, s44
    s_mov_b32 s23, 1
K1_V_LOOP:
    s_waitcnt lgkmcnt(8)
    v_mfma_f32_16x16x32_bf16 v[64:67], v[48:51], v[4:7], v[64:67]
    v_mfma_f32_32x32x16_bf16 v[96:111], v[24:27], v[4:7], v[96:111]
    s_add_u32 s25, s25, 1
    s_cmp_eq_u32 s25, 3
    s_cselect_b32 s24, s47, s46
    v_mfma_f32_32x32x16_bf16 v[176:191], v[28:31], v[4:7], v[176:191]
    ds_read_b64_tr_b16 v[4:5], v46 offset:0
    ds_read_b64_tr_b16 v[6:7], v46 offset:2560
    s_waitcnt lgkmcnt(8)
    v_mfma_f32_32x32x16_bf16 v[112:127], v[24:27], v[8:11], v[112:127]
    ds_read_b128 v[32:35], v41 offset:0
    ds_read_b128 v[36:39], v41 offset:4096
    v_mfma_f32_32x32x16_bf16 v[192:207], v[28:31], v[8:11], v[192:207]
    ds_read_b64_tr_b16 v[8:9], v47 offset:64
    ds_read_b64_tr_b16 v[10:11], v47 offset:2624
    s_waitcnt lgkmcnt(10)
    v_mfma_f32_16x16x32_bf16 v[72:75], v[48:51], v[12:15], v[72:75]
    v_mfma_f32_32x32x16_bf16 v[128:143], v[24:27], v[12:15], v[128:143]
    v_add_u32 v44, s22, v44
    v_add_u32 v45, s22, v45
    v_mfma_f32_32x32x16_bf16 v[208:223], v[28:31], v[12:15], v[208:223]
    ds_read_b64_tr_b16 v[12:13], v46 offset:128
    ds_read_b64_tr_b16 v[14:15], v46 offset:2688
    s_waitcnt lgkmcnt(10)
    v_mfma_f32_32x32x16_bf16 v[144:159], v[24:27], v[16:19], v[144:159]
    v_mfma_f32_32x32x16_bf16 v[224:239], v[28:31], v[16:19], v[224:239]
    ds_read_b64_tr_b16 v[16:17], v47 offset:192
    ds_read_b64_tr_b16 v[18:19], v47 offset:2752
    s_waitcnt lgkmcnt(10)
    v_mfma_f32_16x16x32_bf16 v[80:83], v[48:51], v[20:23], v[80:83]
    v_mfma_f32_32x32x16_bf16 v[160:175], v[24:27], v[20:23], v[160:175]
    s_cmp_eq_u32 s25, 3
    s_cselect_b32 s25, 0, s25
    v_mfma_f32_32x32x16_bf16 v[240:255], v[28:31], v[20:23], v[240:255]
    ds_read_b64_tr_b16 v[20:21], v46 offset:256
    ds_read_b64_tr_b16 v[22:23], v46 offset:2816
    s_waitcnt lgkmcnt(8)
    v_mfma_f32_32x32x16_bf16 v[96:111], v[32:35], v[4:7], v[96:111]
    s_barrier
    v_mfma_f32_32x32x16_bf16 v[176:191], v[36:39], v[4:7], v[176:191]
    ds_read_b64_tr_b16 v[4:5], v44 offset:0
    ds_read_b64_tr_b16 v[6:7], v44 offset:2560
    s_waitcnt lgkmcnt(8)
    v_mfma_f32_16x16x32_bf16 v[68:71], v[48:51], v[8:11], v[68:71]
    v_mfma_f32_32x32x16_bf16 v[112:127], v[32:35], v[8:11], v[112:127]
    ds_read_b128 v[24:27], v42 offset:0
    ds_read_b128 v[28:31], v42 offset:4096
    v_mfma_f32_32x32x16_bf16 v[192:207], v[36:39], v[8:11], v[192:207]
    ds_read_b64_tr_b16 v[8:9], v45 offset:64
    ds_read_b64_tr_b16 v[10:11], v45 offset:2624
    s_waitcnt lgkmcnt(10)
    v_mfma_f32_32x32x16_bf16 v[128:143], v[32:35], v[12:15], v[128:143]
    v_add_u32 v46, s22, v46
    v_add_u32 v47, s22, v47
    v_mfma_f32_32x32x16_bf16 v[208:223], v[36:39], v[12:15], v[208:223]
    ds_read_b64_tr_b16 v[12:13], v44 offset:128
    ds_read_b64_tr_b16 v[14:15], v44 offset:2688
    s_waitcnt lgkmcnt(10)
    v_mfma_f32_16x16x32_bf16 v[76:79], v[48:51], v[16:19], v[76:79]
    v_mfma_f32_32x32x16_bf16 v[144:159], v[32:35], v[16:19], v[144:159]
    v_add_u32 v40, s24, v40
    v_add_u32 v41, s24, v41
    s_add_u32 s23, s23, 1
    s_cmp_eq_u32 s23, 5
    v_mfma_f32_32x32x16_bf16 v[224:239], v[36:39], v[16:19], v[224:239]
    ds_read_b64_tr_b16 v[16:17], v45 offset:192
    ds_read_b64_tr_b16 v[18:19], v45 offset:2752
    s_waitcnt lgkmcnt(10)
    v_mfma_f32_32x32x16_bf16 v[160:175], v[32:35], v[20:23], v[160:175]
    s_cselect_b32 s22, s45, s44
    s_cselect_b32 s23, 0, s23
    v_mfma_f32_32x32x16_bf16 v[240:255], v[36:39], v[20:23], v[240:255]
    ds_read_b64_tr_b16 v[20:21], v44 offset:256
    ds_read_b64_tr_b16 v[22:23], v44 offset:2816
    s_waitcnt lgkmcnt(8)
    v_mfma_f32_16x16x32_bf16 v[64:67], v[48:51], v[4:7], v[64:67]
    v_mfma_f32_32x32x16_bf16 v[96:111], v[24:27], v[4:7], v[96:111]
    v_mfma_f32_32x32x16_bf16 v[176:191], v[28:31], v[4:7], v[176:191]
    ds_read_b64_tr_b16 v[4:5], v46 offset:0
    ds_read_b64_tr_b16 v[6:7], v46 offset:2560
    s_waitcnt lgkmcnt(8)
    v_mfma_f32_32x32x16_bf16 v[112:127], v[24:27], v[8:11], v[112:127]
    ds_read_b128 v[32:35], v43 offset:0
    ds_read_b128 v[36:39], v43 offset:4096
    v_mfma_f32_32x32x16_bf16 v[192:207], v[28:31], v[8:11], v[192:207]
    ds_read_b64_tr_b16 v[8:9], v47 offset:64
    ds_read_b64_tr_b16 v[10:11], v47 offset:2624
    s_waitcnt lgkmcnt(10)
    v_mfma_f32_16x16x32_bf16 v[72:75], v[48:51], v[12:15], v[72:75]
    v_mfma_f32_32x32x16_bf16 v[128:143], v[24:27], v[12:15], v[128:143]
    v_add_u32 v44, s22, v44
    v_add_u32 v45, s22, v45
    v_mfma_f32_32x32x16_bf16 v[208:223], v[28:31], v[12:15], v[208:223]
    ds_read_b64_tr_b16 v[12:13], v46 offset:128
    ds_read_b64_tr_b16 v[14:15], v46 offset:2688
    s_waitcnt lgkmcnt(10)
    v_mfma_f32_32x32x16_bf16 v[144:159], v[24:27], v[16:19], v[144:159]
    v_add_u32 v42, s24, v42
    v_mfma_f32_32x32x16_bf16 v[224:239], v[28:31], v[16:19], v[224:239]
    ds_read_b64_tr_b16 v[16:17], v47 offset:192
    ds_read_b64_tr_b16 v[18:19], v47 offset:2752
    s_waitcnt lgkmcnt(10)
    v_mfma_f32_16x16x32_bf16 v[80:83], v[48:51], v[20:23], v[80:83]
    v_mfma_f32_32x32x16_bf16 v[160:175], v[24:27], v[20:23], v[160:175]
    s_add_u32 s26, s26, 1
    v_mfma_f32_32x32x16_bf16 v[240:255], v[28:31], v[20:23], v[240:255]
    ds_read_b64_tr_b16 v[20:21], v46 offset:256
    ds_read_b64_tr_b16 v[22:23], v46 offset:2816
    s_waitcnt lgkmcnt(8)
    v_mfma_f32_32x32x16_bf16 v[96:111], v[32:35], v[4:7], v[96:111]
    s_barrier
    v_mfma_f32_32x32x16_bf16 v[176:191], v[36:39], v[4:7], v[176:191]
    ds_read_b64_tr_b16 v[4:5], v44 offset:0
    ds_read_b64_tr_b16 v[6:7], v44 offset:2560
    s_waitcnt lgkmcnt(8)
    v_mfma_f32_16x16x32_bf16 v[68:71], v[48:51], v[8:11], v[68:71]
    v_mfma_f32_32x32x16_bf16 v[112:127], v[32:35], v[8:11], v[112:127]
    ds_read_b128 v[24:27], v40 offset:0
    ds_read_b128 v[28:31], v40 offset:4096
    v_mfma_f32_32x32x16_bf16 v[192:207], v[36:39], v[8:11], v[192:207]
    ds_read_b64_tr_b16 v[8:9], v45 offset:64
    ds_read_b64_tr_b16 v[10:11], v45 offset:2624
    s_waitcnt lgkmcnt(10)
    v_mfma_f32_32x32x16_bf16 v[128:143], v[32:35], v[12:15], v[128:143]
    v_add_u32 v46, s22, v46
    v_add_u32 v47, s22, v47
    v_mfma_f32_32x32x16_bf16 v[208:223], v[36:39], v[12:15], v[208:223]
    ds_read_b64_tr_b16 v[12:13], v44 offset:128
    ds_read_b64_tr_b16 v[14:15], v44 offset:2688
    s_waitcnt lgkmcnt(10)
    v_mfma_f32_16x16x32_bf16 v[76:79], v[48:51], v[16:19], v[76:79]
    v_mfma_f32_32x32x16_bf16 v[144:159], v[32:35], v[16:19], v[144:159]
    v_add_u32 v43, s24, v43
    s_add_u32 s23, s23, 1
    s_cmp_eq_u32 s23, 5
    v_mfma_f32_32x32x16_bf16 v[224:239], v[36:39], v[16:19], v[224:239]
    ds_read_b64_tr_b16 v[16:17], v45 offset:192
    ds_read_b64_tr_b16 v[18:19], v45 offset:2752
    s_waitcnt lgkmcnt(10)
    v_mfma_f32_32x32x16_bf16 v[160:175], v[32:35], v[20:23], v[160:175]
    s_cselect_b32 s22, s45, s44
    s_cselect_b32 s23, 0, s23
    s_cmp_lt_u32 s26, 10
    v_mfma_f32_32x32x16_bf16 v[240:255], v[36:39], v[20:23], v[240:255]
    ds_read_b64_tr_b16 v[20:21], v44 offset:256
    ds_read_b64_tr_b16 v[22:23], v44 offset:2816
    s_cbranch_scc1 K1_V_LOOP
    s_nop 7
    s_mov_b64 exec, 0xffff
    ds_write_b32 v62, v64 offset:0
    ds_write_b32 v62, v65 offset:64
    ds_write_b32 v62, v68 offset:128
    ds_write_b32 v62, v69 offset:192
    ds_write_b32 v62, v72 offset:256
    ds_write_b32 v62, v73 offset:320
    ds_write_b32 v62, v76 offset:384
    ds_write_b32 v62, v77 offset:448
    ds_write_b32 v62, v80 offset:512
    ds_write_b32 v62, v81 offset:576
    s_mov_b64 exec, -1
    s_waitcnt lgkmcnt(0)
    s_barrier
    s_barrier
    s_mul_i32 s27, s20, 640
    s_add_u32 s27, s27, 151872
    v_and_b32 v62, 31, v0
    v_lshlrev_b32 v62, 2, v62
    v_add_u32 v62, s27, v62
    ds_read_b32 v76, v62 offset:0
    ds_read_b32 v78, v62 offset:128
    ds_read_b32 v80, v62 offset:256
    ds_read_b32 v82, v62 offset:384
    ds_read_b32 v84, v62 offset:512
    v_lshrrev_b32 v59, 5, v0
    v_lshlrev_b32 v59, 4, v59
    s_lshl_b32 s27, s19, 8
    s_add_u32 s27, s27, 155712
    v_add_u32 v59, s27, v59
    s_add_u32 s4, s34, 5242880
    s_addc_u32 s5, s35, 0
    s_mov_b32 s6, 2621440
    s_mov_b32 s7, 0x00020000
    s_sub_u32 s27, s18, 4
    s_mul_i32 s30, s27, 1310720
    s_lshl_b32 s31, s17, 2
    s_lshl_b32 s27, s19, 1
    s_add_u32 s31, s31, s27
    s_mul_i32 s31, s31, 1280
    s_add_u32 s30, s30, s31
    v_and_b32 v60, 31, v0
    s_mul_i32 s27, s20, 160
    v_add_u32 v60, s27, v60
    v_lshrrev_b32 v61, 5, v0
    v_mul_u32_u24 v61, 320, v61
    v_add_u32 v91, 0, v60
    v_mul_u32_u24 v92, 3277, v91
    v_lshrrev_b32 v92, 16, v92
    v_mul_u32_u24 v93, 20, v92
    v_sub_u32 v91, v91, v93
    v_lshlrev_b32 v91, 4, v91
    v_add_u32 v91, v91, v61
    s_mov_b32 s27, 81920
    v_mul_lo_u32 v92, v92, s27
    v_add_u32 v86, v91, v92
    v_add_u32 v91, 32, v60
    v_mul_u32_u24 v92, 3277, v91
    v_lshrrev_b32 v92, 16, v92
    v_mul_u32_u24 v93, 20, v92
    v_sub_u32 v91, v91, v93
    v_lshlrev_b32 v91, 4, v91
    v_add_u32 v91, v91, v61
    s_mov_b32 s27, 81920
    v_mul_lo_u32 v92, v92, s27
    v_add_u32 v87, v91, v92
    v_add_u32 v91, 64, v60
    v_mul_u32_u24 v92, 3277, v91
    v_lshrrev_b32 v92, 16, v92
    v_mul_u32_u24 v93, 20, v92
    v_sub_u32 v91, v91, v93
    v_lshlrev_b32 v91, 4, v91
    v_add_u32 v91, v91, v61
    s_mov_b32 s27, 81920
    v_mul_lo_u32 v92, v92, s27
    v_add_u32 v88, v91, v92
    v_add_u32 v91, 96, v60
    v_mul_u32_u24 v92, 3277, v91
    v_lshrrev_b32 v92, 16, v92
    v_mul_u32_u24 v93, 20, v92
    v_sub_u32 v91, v91, v93
    v_lshlrev_b32 v91, 4, v91
    v_add_u32 v91, v91, v61
    s_mov_b32 s27, 81920
    v_mul_lo_u32 v92, v92, s27
    v_add_u32 v89, v91, v92
    v_add_u32 v91, 128, v60
    v_mul_u32_u24 v92, 3277, v91
    v_lshrrev_b32 v92, 16, v92
    v_mul_u32_u24 v93, 20, v92
    v_sub_u32 v91, v91, v93
    v_lshlrev_b32 v91, 4, v91
    v_add_u32 v91, v91, v61
    s_mov_b32 s27, 81920
    v_mul_lo_u32 v92, v92, s27
    v_add_u32 v90, v91, v92
    s_waitcnt lgkmcnt(0)
    ds_read_b128 v[4:7], v59 offset:0
    ds_read_b128 v[20:23], v59 offset:512
    ds_read_b128 v[8:11], v59 offset:32
    ds_read_b128 v[24:27], v59 offset:544
    ds_read_b128 v[12:15], v59 offset:64
    ds_read_b128 v[28:31], v59 offset:576
    ds_read_b128 v[16:19], v59 offset:96
    ds_read_b128 v[32:35], v59 offset:608
    s_add_u32 s27, s30, 0
    s_waitcnt lgkmcnt(0)
    v_pk_fma_f32 v[36:37], v[4:5], v[76:77], v[96:97] op_sel:[0,0,0] op_sel_hi:[1,0,1]
    v_pk_fma_f32 v[38:39], v[6:7], v[76:77], v[98:99] op_sel:[0,0,0] op_sel_hi:[1,0,1]
    v_pk_fma_f32 v[40:41], v[8:9], v[76:77], v[100:101] op_sel:[0,0,0] op_sel_hi:[1,0,1]
    v_pk_fma_f32 v[42:43], v[10:11], v[76:77], v[102:103] op_sel:[0,0,0] op_sel_hi:[1,0,1]
    v_pk_mul_f32 v[36:37], v[36:37], v[20:21] op_sel:[0,0] op_sel_hi:[1,1]
    v_pk_mul_f32 v[38:39], v[38:39], v[22:23] op_sel:[0,0] op_sel_hi:[1,1]
    v_pk_mul_f32 v[40:41], v[40:41], v[24:25] op_sel:[0,0] op_sel_hi:[1,1]
    v_pk_mul_f32 v[42:43], v[42:43], v[26:27] op_sel:[0,0] op_sel_hi:[1,1]
    v_cvt_pk_bf16_f32 v96, v36, v37
    v_cvt_pk_bf16_f32 v97, v38, v39
    v_cvt_pk_bf16_f32 v98, v40, v41
    v_cvt_pk_bf16_f32 v99, v42, v43
    buffer_store_dwordx4 v[96:99], v86, s[4:7], s27 offen offset:0 sc1
    v_pk_fma_f32 v[36:37], v[12:13], v[76:77], v[104:105] op_sel:[0,0,0] op_sel_hi:[1,0,1]
    v_pk_fma_f32 v[38:39], v[14:15], v[76:77], v[106:107] op_sel:[0,0,0] op_sel_hi:[1,0,1]
    v_pk_fma_f32 v[40:41], v[16:17], v[76:77], v[108:109] op_sel:[0,0,0] op_sel_hi:[1,0,1]
    v_pk_fma_f32 v[42:43], v[18:19], v[76:77], v[110:111] op_sel:[0,0,0] op_sel_hi:[1,0,1]
    v_pk_mul_f32 v[36:37], v[36:37], v[28:29] op_sel:[0,0] op_sel_hi:[1,1]
    v_pk_mul_f32 v[38:39], v[38:39], v[30:31] op_sel:[0,0] op_sel_hi:[1,1]
    v_pk_mul_f32 v[40:41], v[40:41], v[32:33] op_sel:[0,0] op_sel_hi:[1,1]
    v_pk_mul_f32 v[42:43], v[42:43], v[34:35] op_sel:[0,0] op_sel_hi:[1,1]
    v_cvt_pk_bf16_f32 v104, v36, v37
    v_cvt_pk_bf16_f32 v105, v38, v39
    v_cvt_pk_bf16_f32 v106, v40, v41
    v_cvt_pk_bf16_f32 v107, v42, v43
    buffer_store_dwordx4 v[104:107], v86, s[4:7], s27 offen offset:640 sc1
    v_pk_fma_f32 v[36:37], v[4:5], v[78:79], v[112:113] op_sel:[0,0,0] op_sel_hi:[1,0,1]
    v_pk_fma_f32 v[38:39], v[6:7], v[78:79], v[114:115] op_sel:[0,0,0] op_sel_hi:[1,0,1]
    v_pk_fma_f32 v[40:41], v[8:9], v[78:79], v[116:117] op_sel:[0,0,0] op_sel_hi:[1,0,1]
    v_pk_fma_f32 v[42:43], v[10:11], v[78:79], v[118:119] op_sel:[0,0,0] op_sel_hi:[1,0,1]
    v_pk_mul_f32 v[36:37], v[36:37], v[20:21] op_sel:[0,0] op_sel_hi:[1,1]
    v_pk_mul_f32 v[38:39], v[38:39], v[22:23] op_sel:[0,0] op_sel_hi:[1,1]
    v_pk_mul_f32 v[40:41], v[40:41], v[24:25] op_sel:[0,0] op_sel_hi:[1,1]
    v_pk_mul_f32 v[42:43], v[42:43], v[26:27] op_sel:[0,0] op_sel_hi:[1,1]
    v_cvt_pk_bf16_f32 v112, v36, v37
    v_cvt_pk_bf16_f32 v113, v38, v39
    v_cvt_pk_bf16_f32 v114, v40, v41
    v_cvt_pk_bf16_f32 v115, v42, v43
    buffer_store_dwordx4 v[112:115], v87, s[4:7], s27 offen offset:0 sc1
    v_pk_fma_f32 v[36:37], v[12:13], v[78:79], v[120:121] op_sel:[0,0,0] op_sel_hi:[1,0,1]
    v_pk_fma_f32 v[38:39], v[14:15], v[78:79], v[122:123] op_sel:[0,0,0] op_sel_hi:[1,0,1]
    v_pk_fma_f32 v[40:41], v[16:17], v[78:79], v[124:125] op_sel:[0,0,0] op_sel_hi:[1,0,1]
    v_pk_fma_f32 v[42:43], v[18:19], v[78:79], v[126:127] op_sel:[0,0,0] op_sel_hi:[1,0,1]
    v_pk_mul_f32 v[36:37], v[36:37], v[28:29] op_sel:[0,0] op_sel_hi:[1,1]
    v_pk_mul_f32 v[38:39], v[38:39], v[30:31] op_sel:[0,0] op_sel_hi:[1,1]
    v_pk_mul_f32 v[40:41], v[40:41], v[32:33] op_sel:[0,0] op_sel_hi:[1,1]
    v_pk_mul_f32 v[42:43], v[42:43], v[34:35] op_sel:[0,0] op_sel_hi:[1,1]
    v_cvt_pk_bf16_f32 v120, v36, v37
    v_cvt_pk_bf16_f32 v121, v38, v39
    v_cvt_pk_bf16_f32 v122, v40, v41
    v_cvt_pk_bf16_f32 v123, v42, v43
    buffer_store_dwordx4 v[120:123], v87, s[4:7], s27 offen offset:640 sc1
    v_pk_fma_f32 v[36:37], v[4:5], v[80:81], v[128:129] op_sel:[0,0,0] op_sel_hi:[1,0,1]
    v_pk_fma_f32 v[38:39], v[6:7], v[80:81], v[130:131] op_sel:[0,0,0] op_sel_hi:[1,0,1]
    v_pk_fma_f32 v[40:41], v[8:9], v[80:81], v[132:133] op_sel:[0,0,0] op_sel_hi:[1,0,1]
    v_pk_fma_f32 v[42:43], v[10:11], v[80:81], v[134:135] op_sel:[0,0,0] op_sel_hi:[1,0,1]
    v_pk_mul_f32 v[36:37], v[36:37], v[20:21] op_sel:[0,0] op_sel_hi:[1,1]
    v_pk_mul_f32 v[38:39], v[38:39], v[22:23] op_sel:[0,0] op_sel_hi:[1,1]
    v_pk_mul_f32 v[40:41], v[40:41], v[24:25] op_sel:[0,0] op_sel_hi:[1,1]
    v_pk_mul_f32 v[42:43], v[42:43], v[26:27] op_sel:[0,0] op_sel_hi:[1,1]
    v_cvt_pk_bf16_f32 v128, v36, v37
    v_cvt_pk_bf16_f32 v129, v38, v39
    v_cvt_pk_bf16_f32 v130, v40, v41
    v_cvt_pk_bf16_f32 v131, v42, v43
    buffer_store_dwordx4 v[128:131], v88, s[4:7], s27 offen offset:0 sc1
    v_pk_fma_f32 v[36:37], v[12:13], v[80:81], v[136:137] op_sel:[0,0,0] op_sel_hi:[1,0,1]
    v_pk_fma_f32 v[38:39], v[14:15], v[80:81], v[138:139] op_sel:[0,0,0] op_sel_hi:[1,0,1]
    v_pk_fma_f32 v[40:41], v[16:17], v[80:81], v[140:141] op_sel:[0,0,0] op_sel_hi:[1,0,1]
    v_pk_fma_f32 v[42:43], v[18:19], v[80:81], v[142:143] op_sel:[0,0,0] op_sel_hi:[1,0,1]
    v_pk_mul_f32 v[36:37], v[36:37], v[28:29] op_sel:[0,0] op_sel_hi:[1,1]
    v_pk_mul_f32 v[38:39], v[38:39], v[30:31] op_sel:[0,0] op_sel_hi:[1,1]
    v_pk_mul_f32 v[40:41], v[40:41], v[32:33] op_sel:[0,0] op_sel_hi:[1,1]
    v_pk_mul_f32 v[42:43], v[42:43], v[34:35] op_sel:[0,0] op_sel_hi:[1,1]
    v_cvt_pk_bf16_f32 v136, v36, v37
    v_cvt_pk_bf16_f32 v137, v38, v39
    v_cvt_pk_bf16_f32 v138, v40, v41
    v_cvt_pk_bf16_f32 v139, v42, v43
    buffer_store_dwordx4 v[136:139], v88, s[4:7], s27 offen offset:640 sc1
    v_pk_fma_f32 v[36:37], v[4:5], v[82:83], v[144:145] op_sel:[0,0,0] op_sel_hi:[1,0,1]
    v_pk_fma_f32 v[38:39], v[6:7], v[82:83], v[146:147] op_sel:[0,0,0] op_sel_hi:[1,0,1]
    v_pk_fma_f32 v[40:41], v[8:9], v[82:83], v[148:149] op_sel:[0,0,0] op_sel_hi:[1,0,1]
    v_pk_fma_f32 v[42:43], v[10:11], v[82:83], v[150:151] op_sel:[0,0,0] op_sel_hi:[1,0,1]
    v_pk_mul_f32 v[36:37], v[36:37], v[20:21] op_sel:[0,0] op_sel_hi:[1,1]
    v_pk_mul_f32 v[38:39], v[38:39], v[22:23] op_sel:[0,0] op_sel_hi:[1,1]
    v_pk_mul_f32 v[40:41], v[40:41], v[24:25] op_sel:[0,0] op_sel_hi:[1,1]
    v_pk_mul_f32 v[42:43], v[42:43], v[26:27] op_sel:[0,0] op_sel_hi:[1,1]
    v_cvt_pk_bf16_f32 v144, v36, v37
    v_cvt_pk_bf16_f32 v145, v38, v39
    v_cvt_pk_bf16_f32 v146, v40, v41
    v_cvt_pk_bf16_f32 v147, v42, v43
    buffer_store_dwordx4 v[144:147], v89, s[4:7], s27 offen offset:0 sc1
    v_pk_fma_f32 v[36:37], v[12:13], v[82:83], v[152:153] op_sel:[0,0,0] op_sel_hi:[1,0,1]
    v_pk_fma_f32 v[38:39], v[14:15], v[82:83], v[154:155] op_sel:[0,0,0] op_sel_hi:[1,0,1]
    v_pk_fma_f32 v[40:41], v[16:17], v[82:83], v[156:157] op_sel:[0,0,0] op_sel_hi:[1,0,1]
    v_pk_fma_f32 v[42:43], v[18:19], v[82:83], v[158:159] op_sel:[0,0,0] op_sel_hi:[1,0,1]
    v_pk_mul_f32 v[36:37], v[36:37], v[28:29] op_sel:[0,0] op_sel_hi:[1,1]
    v_pk_mul_f32 v[38:39], v[38:39], v[30:31] op_sel:[0,0] op_sel_hi:[1,1]
    v_pk_mul_f32 v[40:41], v[40:41], v[32:33] op_sel:[0,0] op_sel_hi:[1,1]
    v_pk_mul_f32 v[42:43], v[42:43], v[34:35] op_sel:[0,0] op_sel_hi:[1,1]
    v_cvt_pk_bf16_f32 v152, v36, v37
    v_cvt_pk_bf16_f32 v153, v38, v39
    v_cvt_pk_bf16_f32 v154, v40, v41
    v_cvt_pk_bf16_f32 v155, v42, v43
    buffer_store_dwordx4 v[152:155], v89, s[4:7], s27 offen offset:640 sc1
    v_pk_fma_f32 v[36:37], v[4:5], v[84:85], v[160:161] op_sel:[0,0,0] op_sel_hi:[1,0,1]
    v_pk_fma_f32 v[38:39], v[6:7], v[84:85], v[162:163] op_sel:[0,0,0] op_sel_hi:[1,0,1]
    v_pk_fma_f32 v[40:41], v[8:9], v[84:85], v[164:165] op_sel:[0,0,0] op_sel_hi:[1,0,1]
    v_pk_fma_f32 v[42:43], v[10:11], v[84:85], v[166:167] op_sel:[0,0,0] op_sel_hi:[1,0,1]
    v_pk_mul_f32 v[36:37], v[36:37], v[20:21] op_sel:[0,0] op_sel_hi:[1,1]
    v_pk_mul_f32 v[38:39], v[38:39], v[22:23] op_sel:[0,0] op_sel_hi:[1,1]
    v_pk_mul_f32 v[40:41], v[40:41], v[24:25] op_sel:[0,0] op_sel_hi:[1,1]
    v_pk_mul_f32 v[42:43], v[42:43], v[26:27] op_sel:[0,0] op_sel_hi:[1,1]
    v_cvt_pk_bf16_f32 v160, v36, v37
    v_cvt_pk_bf16_f32 v161, v38, v39
    v_cvt_pk_bf16_f32 v162, v40, v41
    v_cvt_pk_bf16_f32 v163, v42, v43
    buffer_store_dwordx4 v[160:163], v90, s[4:7], s27 offen offset:0 sc1
    v_pk_fma_f32 v[36:37], v[12:13], v[84:85], v[168:169] op_sel:[0,0,0] op_sel_hi:[1,0,1]
    v_pk_fma_f32 v[38:39], v[14:15], v[84:85], v[170:171] op_sel:[0,0,0] op_sel_hi:[1,0,1]
    v_pk_fma_f32 v[40:41], v[16:17], v[84:85], v[172:173] op_sel:[0,0,0] op_sel_hi:[1,0,1]
    v_pk_fma_f32 v[42:43], v[18:19], v[84:85], v[174:175] op_sel:[0,0,0] op_sel_hi:[1,0,1]
    v_pk_mul_f32 v[36:37], v[36:37], v[28:29] op_sel:[0,0] op_sel_hi:[1,1]
    v_pk_mul_f32 v[38:39], v[38:39], v[30:31] op_sel:[0,0] op_sel_hi:[1,1]
    v_pk_mul_f32 v[40:41], v[40:41], v[32:33] op_sel:[0,0] op_sel_hi:[1,1]
    v_pk_mul_f32 v[42:43], v[42:43], v[34:35] op_sel:[0,0] op_sel_hi:[1,1]
    v_cvt_pk_bf16_f32 v168, v36, v37
    v_cvt_pk_bf16_f32 v169, v38, v39
    v_cvt_pk_bf16_f32 v170, v40, v41
    v_cvt_pk_bf16_f32 v171, v42, v43
    buffer_store_dwordx4 v[168:171], v90, s[4:7], s27 offen offset:640 sc1
    s_waitcnt lgkmcnt(0)
    ds_read_b128 v[4:7], v59 offset:128
    ds_read_b128 v[20:23], v59 offset:640
    ds_read_b128 v[8:11], v59 offset:160
    ds_read_b128 v[24:27], v59 offset:672
    ds_read_b128 v[12:15], v59 offset:192
    ds_read_b128 v[28:31], v59 offset:704
    ds_read_b128 v[16:19], v59 offset:224
    ds_read_b128 v[32:35], v59 offset:736
    s_add_u32 s27, s30, 1280
    s_waitcnt lgkmcnt(0)
    v_pk_fma_f32 v[36:37], v[4:5], v[76:77], v[176:177] op_sel:[0,0,0] op_sel_hi:[1,0,1]
    v_pk_fma_f32 v[38:39], v[6:7], v[76:77], v[178:179] op_sel:[0,0,0] op_sel_hi:[1,0,1]
    v_pk_fma_f32 v[40:41], v[8:9], v[76:77], v[180:181] op_sel:[0,0,0] op_sel_hi:[1,0,1]
    v_pk_fma_f32 v[42:43], v[10:11], v[76:77], v[182:183] op_sel:[0,0,0] op_sel_hi:[1,0,1]
    v_pk_mul_f32 v[36:37], v[36:37], v[20:21] op_sel:[0,0] op_sel_hi:[1,1]
    v_pk_mul_f32 v[38:39], v[38:39], v[22:23] op_sel:[0,0] op_sel_hi:[1,1]
    v_pk_mul_f32 v[40:41], v[40:41], v[24:25] op_sel:[0,0] op_sel_hi:[1,1]
    v_pk_mul_f32 v[42:43], v[42:43], v[26:27] op_sel:[0,0] op_sel_hi:[1,1]
    v_cvt_pk_bf16_f32 v176, v36, v37
    v_cvt_pk_bf16_f32 v177, v38, v39
    v_cvt_pk_bf16_f32 v178, v40, v41
    v_cvt_pk_bf16_f32 v179, v42, v43
    buffer_store_dwordx4 v[176:179], v86, s[4:7], s27 offen offset:0 sc1
    v_pk_fma_f32 v[36:37], v[12:13], v[76:77], v[184:185] op_sel:[0,0,0] op_sel_hi:[1,0,1]
    v_pk_fma_f32 v[38:39], v[14:15], v[76:77], v[186:187] op_sel:[0,0,0] op_sel_hi:[1,0,1]
    v_pk_fma_f32 v[40:41], v[16:17], v[76:77], v[188:189] op_sel:[0,0,0] op_sel_hi:[1,0,1]
    v_pk_fma_f32 v[42:43], v[18:19], v[76:77], v[190:191] op_sel:[0,0,0] op_sel_hi:[1,0,1]
    v_pk_mul_f32 v[36:37], v[36:37], v[28:29] op_sel:[0,0] op_sel_hi:[1,1]
    v_pk_mul_f32 v[38:39], v[38:39], v[30:31] op_sel:[0,0] op_sel_hi:[1,1]
    v_pk_mul_f32 v[40:41], v[40:41], v[32:33] op_sel:[0,0] op_sel_hi:[1,1]
    v_pk_mul_f32 v[42:43], v[42:43], v[34:35] op_sel:[0,0] op_sel_hi:[1,1]
    v_cvt_pk_bf16_f32 v184, v36, v37
    v_cvt_pk_bf16_f32 v185, v38, v39
    v_cvt_pk_bf16_f32 v186, v40, v41
    v_cvt_pk_bf16_f32 v187, v42, v43
    buffer_store_dwordx4 v[184:187], v86, s[4:7], s27 offen offset:640 sc1
    v_pk_fma_f32 v[36:37], v[4:5], v[78:79], v[192:193] op_sel:[0,0,0] op_sel_hi:[1,0,1]
    v_pk_fma_f32 v[38:39], v[6:7], v[78:79], v[194:195] op_sel:[0,0,0] op_sel_hi:[1,0,1]
    v_pk_fma_f32 v[40:41], v[8:9], v[78:79], v[196:197] op_sel:[0,0,0] op_sel_hi:[1,0,1]
    v_pk_fma_f32 v[42:43], v[10:11], v[78:79], v[198:199] op_sel:[0,0,0] op_sel_hi:[1,0,1]
    v_pk_mul_f32 v[36:37], v[36:37], v[20:21] op_sel:[0,0] op_sel_hi:[1,1]
    v_pk_mul_f32 v[38:39], v[38:39], v[22:23] op_sel:[0,0] op_sel_hi:[1,1]
    v_pk_mul_f32 v[40:41], v[40:41], v[24:25] op_sel:[0,0] op_sel_hi:[1,1]
    v_pk_mul_f32 v[42:43], v[42:43], v[26:27] op_sel:[0,0] op_sel_hi:[1,1]
    v_cvt_pk_bf16_f32 v192, v36, v37
    v_cvt_pk_bf16_f32 v193, v38, v39
    v_cvt_pk_bf16_f32 v194, v40, v41
    v_cvt_pk_bf16_f32 v195, v42, v43
    buffer_store_dwordx4 v[192:195], v87, s[4:7], s27 offen offset:0 sc1
    v_pk_fma_f32 v[36:37], v[12:13], v[78:79], v[200:201] op_sel:[0,0,0] op_sel_hi:[1,0,1]
    v_pk_fma_f32 v[38:39], v[14:15], v[78:79], v[202:203] op_sel:[0,0,0] op_sel_hi:[1,0,1]
    v_pk_fma_f32 v[40:41], v[16:17], v[78:79], v[204:205] op_sel:[0,0,0] op_sel_hi:[1,0,1]
    v_pk_fma_f32 v[42:43], v[18:19], v[78:79], v[206:207] op_sel:[0,0,0] op_sel_hi:[1,0,1]
    v_pk_mul_f32 v[36:37], v[36:37], v[28:29] op_sel:[0,0] op_sel_hi:[1,1]
    v_pk_mul_f32 v[38:39], v[38:39], v[30:31] op_sel:[0,0] op_sel_hi:[1,1]
    v_pk_mul_f32 v[40:41], v[40:41], v[32:33] op_sel:[0,0] op_sel_hi:[1,1]
    v_pk_mul_f32 v[42:43], v[42:43], v[34:35] op_sel:[0,0] op_sel_hi:[1,1]
    v_cvt_pk_bf16_f32 v200, v36, v37
    v_cvt_pk_bf16_f32 v201, v38, v39
    v_cvt_pk_bf16_f32 v202, v40, v41
    v_cvt_pk_bf16_f32 v203, v42, v43
    buffer_store_dwordx4 v[200:203], v87, s[4:7], s27 offen offset:640 sc1
    v_pk_fma_f32 v[36:37], v[4:5], v[80:81], v[208:209] op_sel:[0,0,0] op_sel_hi:[1,0,1]
    v_pk_fma_f32 v[38:39], v[6:7], v[80:81], v[210:211] op_sel:[0,0,0] op_sel_hi:[1,0,1]
    v_pk_fma_f32 v[40:41], v[8:9], v[80:81], v[212:213] op_sel:[0,0,0] op_sel_hi:[1,0,1]
    v_pk_fma_f32 v[42:43], v[10:11], v[80:81], v[214:215] op_sel:[0,0,0] op_sel_hi:[1,0,1]
    v_pk_mul_f32 v[36:37], v[36:37], v[20:21] op_sel:[0,0] op_sel_hi:[1,1]
    v_pk_mul_f32 v[38:39], v[38:39], v[22:23] op_sel:[0,0] op_sel_hi:[1,1]
    v_pk_mul_f32 v[40:41], v[40:41], v[24:25] op_sel:[0,0] op_sel_hi:[1,1]
    v_pk_mul_f32 v[42:43], v[42:43], v[26:27] op_sel:[0,0] op_sel_hi:[1,1]
    v_cvt_pk_bf16_f32 v208, v36, v37
    v_cvt_pk_bf16_f32 v209, v38, v39
    v_cvt_pk_bf16_f32 v210, v40, v41
    v_cvt_pk_bf16_f32 v211, v42, v43
    buffer_store_dwordx4 v[208:211], v88, s[4:7], s27 offen offset:0 sc1
    v_pk_fma_f32 v[36:37], v[12:13], v[80:81], v[216:217] op_sel:[0,0,0] op_sel_hi:[1,0,1]
    v_pk_fma_f32 v[38:39], v[14:15], v[80:81], v[218:219] op_sel:[0,0,0] op_sel_hi:[1,0,1]
    v_pk_fma_f32 v[40:41], v[16:17], v[80:81], v[220:221] op_sel:[0,0,0] op_sel_hi:[1,0,1]
    v_pk_fma_f32 v[42:43], v[18:19], v[80:81], v[222:223] op_sel:[0,0,0] op_sel_hi:[1,0,1]
    v_pk_mul_f32 v[36:37], v[36:37], v[28:29] op_sel:[0,0] op_sel_hi:[1,1]
    v_pk_mul_f32 v[38:39], v[38:39], v[30:31] op_sel:[0,0] op_sel_hi:[1,1]
    v_pk_mul_f32 v[40:41], v[40:41], v[32:33] op_sel:[0,0] op_sel_hi:[1,1]
    v_pk_mul_f32 v[42:43], v[42:43], v[34:35] op_sel:[0,0] op_sel_hi:[1,1]
    v_cvt_pk_bf16_f32 v216, v36, v37
    v_cvt_pk_bf16_f32 v217, v38, v39
    v_cvt_pk_bf16_f32 v218, v40, v41
    v_cvt_pk_bf16_f32 v219, v42, v43
    buffer_store_dwordx4 v[216:219], v88, s[4:7], s27 offen offset:640 sc1
    v_pk_fma_f32 v[36:37], v[4:5], v[82:83], v[224:225] op_sel:[0,0,0] op_sel_hi:[1,0,1]
    v_pk_fma_f32 v[38:39], v[6:7], v[82:83], v[226:227] op_sel:[0,0,0] op_sel_hi:[1,0,1]
    v_pk_fma_f32 v[40:41], v[8:9], v[82:83], v[228:229] op_sel:[0,0,0] op_sel_hi:[1,0,1]
    v_pk_fma_f32 v[42:43], v[10:11], v[82:83], v[230:231] op_sel:[0,0,0] op_sel_hi:[1,0,1]
    v_pk_mul_f32 v[36:37], v[36:37], v[20:21] op_sel:[0,0] op_sel_hi:[1,1]
    v_pk_mul_f32 v[38:39], v[38:39], v[22:23] op_sel:[0,0] op_sel_hi:[1,1]
    v_pk_mul_f32 v[40:41], v[40:41], v[24:25] op_sel:[0,0] op_sel_hi:[1,1]
    v_pk_mul_f32 v[42:43], v[42:43], v[26:27] op_sel:[0,0] op_sel_hi:[1,1]
    v_cvt_pk_bf16_f32 v224, v36, v37
    v_cvt_pk_bf16_f32 v225, v38, v39
    v_cvt_pk_bf16_f32 v226, v40, v41
    v_cvt_pk_bf16_f32 v227, v42, v43
    buffer_store_dwordx4 v[224:227], v89, s[4:7], s27 offen offset:0 sc1
    v_pk_fma_f32 v[36:37], v[12:13], v[82:83], v[232:233] op_sel:[0,0,0] op_sel_hi:[1,0,1]
    v_pk_fma_f32 v[38:39], v[14:15], v[82:83], v[234:235] op_sel:[0,0,0] op_sel_hi:[1,0,1]
    v_pk_fma_f32 v[40:41], v[16:17], v[82:83], v[236:237] op_sel:[0,0,0] op_sel_hi:[1,0,1]
    v_pk_fma_f32 v[42:43], v[18:19], v[82:83], v[238:239] op_sel:[0,0,0] op_sel_hi:[1,0,1]
    v_pk_mul_f32 v[36:37], v[36:37], v[28:29] op_sel:[0,0] op_sel_hi:[1,1]
    v_pk_mul_f32 v[38:39], v[38:39], v[30:31] op_sel:[0,0] op_sel_hi:[1,1]
    v_pk_mul_f32 v[40:41], v[40:41], v[32:33] op_sel:[0,0] op_sel_hi:[1,1]
    v_pk_mul_f32 v[42:43], v[42:43], v[34:35] op_sel:[0,0] op_sel_hi:[1,1]
    v_cvt_pk_bf16_f32 v232, v36, v37
    v_cvt_pk_bf16_f32 v233, v38, v39
    v_cvt_pk_bf16_f32 v234, v40, v41
    v_cvt_pk_bf16_f32 v235, v42, v43
    buffer_store_dwordx4 v[232:235], v89, s[4:7], s27 offen offset:640 sc1
    v_pk_fma_f32 v[36:37], v[4:5], v[84:85], v[240:241] op_sel:[0,0,0] op_sel_hi:[1,0,1]
    v_pk_fma_f32 v[38:39], v[6:7], v[84:85], v[242:243] op_sel:[0,0,0] op_sel_hi:[1,0,1]
    v_pk_fma_f32 v[40:41], v[8:9], v[84:85], v[244:245] op_sel:[0,0,0] op_sel_hi:[1,0,1]
    v_pk_fma_f32 v[42:43], v[10:11], v[84:85], v[246:247] op_sel:[0,0,0] op_sel_hi:[1,0,1]
    v_pk_mul_f32 v[36:37], v[36:37], v[20:21] op_sel:[0,0] op_sel_hi:[1,1]
    v_pk_mul_f32 v[38:39], v[38:39], v[22:23] op_sel:[0,0] op_sel_hi:[1,1]
    v_pk_mul_f32 v[40:41], v[40:41], v[24:25] op_sel:[0,0] op_sel_hi:[1,1]
    v_pk_mul_f32 v[42:43], v[42:43], v[26:27] op_sel:[0,0] op_sel_hi:[1,1]
    v_cvt_pk_bf16_f32 v240, v36, v37
    v_cvt_pk_bf16_f32 v241, v38, v39
    v_cvt_pk_bf16_f32 v242, v40, v41
    v_cvt_pk_bf16_f32 v243, v42, v43
    buffer_store_dwordx4 v[240:243], v90, s[4:7], s27 offen offset:0 sc1
    v_pk_fma_f32 v[36:37], v[12:13], v[84:85], v[248:249] op_sel:[0,0,0] op_sel_hi:[1,0,1]
    v_pk_fma_f32 v[38:39], v[14:15], v[84:85], v[250:251] op_sel:[0,0,0] op_sel_hi:[1,0,1]
    v_pk_fma_f32 v[40:41], v[16:17], v[84:85], v[252:253] op_sel:[0,0,0] op_sel_hi:[1,0,1]
    v_pk_fma_f32 v[42:43], v[18:19], v[84:85], v[254:255] op_sel:[0,0,0] op_sel_hi:[1,0,1]
    v_pk_mul_f32 v[36:37], v[36:37], v[28:29] op_sel:[0,0] op_sel_hi:[1,1]
    v_pk_mul_f32 v[38:39], v[38:39], v[30:31] op_sel:[0,0] op_sel_hi:[1,1]
    v_pk_mul_f32 v[40:41], v[40:41], v[32:33] op_sel:[0,0] op_sel_hi:[1,1]
    v_pk_mul_f32 v[42:43], v[42:43], v[34:35] op_sel:[0,0] op_sel_hi:[1,1]
    v_cvt_pk_bf16_f32 v248, v36, v37
    v_cvt_pk_bf16_f32 v249, v38, v39
    v_cvt_pk_bf16_f32 v250, v40, v41
    v_cvt_pk_bf16_f32 v251, v42, v43
    buffer_store_dwordx4 v[248:251], v90, s[4:7], s27 offen offset:640 sc1
    s_branch K1_DONE
K1_FFN_SETUP:
    v_mul_u32_u24 v59, 320, v88
    v_mul_u32_u24 v60, 10272, v85
    v_add_u32 v59, v59, v60
    v_lshlrev_b32 v60, 3, v87
    v_add_u32 v59, v59, v60
    s_mul_i32 s27, s20, 160
    s_add_u32 s27, s27, 49152
    v_add_u32 v59, s27, v59
    s_xor_b32 s27, s21, 0
    s_mul_i32 s27, s27, 5120
    v_add_u32 v44, s27, v59
    s_xor_b32 s27, s21, 1
    s_mul_i32 s27, s27, 5120
    v_add_u32 v46, s27, v59
    v_and_b32 v62, 15, v0
    v_lshlrev_b32 v62, 2, v62
    s_mul_i32 s27, s20, 320
    s_mul_i32 s29, s19, 1280
    s_add_u32 s27, s27, s29
    s_add_u32 s27, s27, 153152
    v_add_u32 v62, s27, v62
    v_mov_b32 v96, 0
    v_mov_b32 v97, 0
    v_mov_b32 v98, 0
    v_mov_b32 v99, 0
    v_mov_b32 v100, 0
    v_mov_b32 v101, 0
    v_mov_b32 v102, 0
    v_mov_b32 v103, 0
    v_mov_b32 v104, 0
    v_mov_b32 v105, 0
    v_mov_b32 v106, 0
    v_mov_b32 v107, 0
    v_mov_b32 v108, 0
    v_mov_b32 v109, 0
    v_mov_b32 v110, 0
    v_mov_b32 v111, 0
    v_mov_b32 v112, 0
    v_mov_b32 v113, 0
    v_mov_b32 v114, 0
    v_mov_b32 v115, 0
    v_mov_b32 v116, 0
    v_mov_b32 v117, 0
    v_mov_b32 v118, 0
    v_mov_b32 v119, 0
    v_mov_b32 v120, 0
    v_mov_b32 v121, 0
    v_mov_b32 v122, 0
    v_mov_b32 v123, 0
    v_mov_b32 v124, 0
    v_mov_b32 v125, 0
    v_mov_b32 v126, 0
    v_mov_b32 v127, 0
    v_mov_b32 v128, 0
    v_mov_b32 v129, 0
    v_mov_b32 v130, 0
    v_mov_b32 v131, 0
    v_mov_b32 v132, 0
    v_mov_b32 v133, 0
    v_mov_b32 v134, 0
    v_mov_b32 v135, 0
    v_mov_b32 v136, 0
    v_mov_b32 v137, 0
    v_mov_b32 v138, 0
    v_mov_b32 v139, 0
    v_mov_b32 v140, 0
    v_mov_b32 v141, 0
    v_mov_b32 v142, 0
    v_mov_b32 v143, 0
    v_mov_b32 v144, 0
    v_mov_b32 v145, 0
    v_mov_b32 v146, 0
    v_mov_b32 v147, 0
    v_mov_b32 v148, 0
    v_mov_b32 v149, 0
    v_mov_b32 v150, 0
    v_mov_b32 v151, 0
    v_mov_b32 v152, 0
    v_mov_b32 v153, 0
    v_mov_b32 v154, 0
    v_mov_b32 v155, 0
    v_mov_b32 v156, 0
    v_mov_b32 v157, 0
    v_mov_b32 v158, 0
    v_mov_b32 v159, 0
    v_mov_b32 v160, 0
    v_mov_b32 v161, 0
    v_mov_b32 v162, 0
    v_mov_b32 v163, 0
    v_mov_b32 v164, 0
    v_mov_b32 v165, 0
    v_mov_b32 v166, 0
    v_mov_b32 v167, 0
    v_mov_b32 v168, 0
    v_mov_b32 v169, 0
    v_mov_b32 v170, 0
    v_mov_b32 v171, 0
    v_mov_b32 v172, 0
    v_mov_b32 v173, 0
    v_mov_b32 v174, 0
    v_mov_b32 v175, 0
    v_mov_b32 v176, 0
    v_mov_b32 v177, 0
    v_mov_b32 v178, 0
    v_mov_b32 v179, 0
    v_mov_b32 v180, 0
    v_mov_b32 v181, 0
    v_mov_b32 v182, 0
    v_mov_b32 v183, 0
    v_mov_b32 v184, 0
    v_mov_b32 v185, 0
    v_mov_b32 v186, 0
    v_mov_b32 v187, 0
    v_mov_b32 v188, 0
    v_mov_b32 v189, 0
    v_mov_b32 v190, 0
    v_mov_b32 v191, 0
    v_mov_b32 v192, 0
    v_mov_b32 v193, 0
    v_mov_b32 v194, 0
    v_mov_b32 v195, 0
    v_mov_b32 v196, 0
    v_mov_b32 v197, 0
    v_mov_b32 v198, 0
    v_mov_b32 v199, 0
    v_mov_b32 v200, 0
    v_mov_b32 v201, 0
    v_mov_b32 v202, 0
    v_mov_b32 v203, 0
    v_mov_b32 v204, 0
    v_mov_b32 v205, 0
    v_mov_b32 v206, 0
    v_mov_b32 v207, 0
    v_mov_b32 v208, 0
    v_mov_b32 v209, 0
    v_mov_b32 v210, 0
    v_mov_b32 v211, 0
    v_mov_b32 v212, 0
    v_mov_b32 v213, 0
    v_mov_b32 v214, 0
    v_mov_b32 v215, 0
    v_mov_b32 v216, 0
    v_mov_b32 v217, 0
    v_mov_b32 v218, 0
    v_mov_b32 v219, 0
    v_mov_b32 v220, 0
    v_mov_b32 v221, 0
    v_mov_b32 v222, 0
    v_mov_b32 v223, 0
    v_mov_b32 v224, 0
    v_mov_b32 v225, 0
    v_mov_b32 v226, 0
    v_mov_b32 v227, 0
    v_mov_b32 v228, 0
    v_mov_b32 v229, 0
    v_mov_b32 v230, 0
    v_mov_b32 v231, 0
    v_mov_b32 v232, 0
    v_mov_b32 v233, 0
    v_mov_b32 v234, 0
    v_mov_b32 v235, 0
    v_mov_b32 v236, 0
    v_mov_b32 v237, 0
    v_mov_b32 v238, 0
    v_mov_b32 v239, 0
    v_mov_b32 v240, 0
    v_mov_b32 v241, 0
    v_mov_b32 v242, 0
    v_mov_b32 v243, 0
    v_mov_b32 v244, 0
    v_mov_b32 v245, 0
    v_mov_b32 v246, 0
    v_mov_b32 v247, 0
    v_mov_b32 v248, 0
    v_mov_b32 v249, 0
    v_mov_b32 v250, 0
    v_mov_b32 v251, 0
    v_mov_b32 v252, 0
    v_mov_b32 v253, 0
    v_mov_b32 v254, 0
    v_mov_b32 v255, 0
    s_waitcnt lgkmcnt(0)
    s_barrier
    ds_read_b64_tr_b16 v[4:5], v44 offset:0
    ds_read_b64_tr_b16 v[6:7], v44 offset:1280
    ds_read_b128 v[24:27], v40 offset:0
    ds_read_b128 v[28:31], v40 offset:4096
    ds_read_b64_tr_b16 v[8:9], v44 offset:32
    ds_read_b64_tr_b16 v[10:11], v44 offset:1312
    ds_read_b64_tr_b16 v[12:13], v44 offset:64
    ds_read_b64_tr_b16 v[14:15], v44 offset:1344
    ds_read_b64_tr_b16 v[16:17], v44 offset:96
    ds_read_b64_tr_b16 v[18:19], v44 offset:1376
    ds_read_b64_tr_b16 v[20:21], v44 offset:128
    ds_read_b64_tr_b16 v[22:23], v44 offset:1408
    s_mov_b32 s26, 0
    s_mov_b32 s22, s44
    s_mov_b32 s23, 1
K1_FFN_LOOP:
    s_waitcnt lgkmcnt(8)
    v_mfma_f32_16x16x32_bf16 v[64:67], v[48:51], v[4:7], v[64:67]
    v_mfma_f32_32x32x16_bf16 v[96:111], v[4:7], v[24:27], v[96:111]
    s_add_u32 s25, s25, 1
    s_cmp_eq_u32 s25, 3
    s_cselect_b32 s24, s47, s46
    v_mfma_f32_32x32x16_bf16 v[176:191], v[4:7], v[28:31], v[176:191]
    ds_read_b64_tr_b16 v[4:5], v46 offset:0
    ds_read_b64_tr_b16 v[6:7], v46 offset:1280
    s_waitcnt lgkmcnt(8)
    v_mfma_f32_32x32x16_bf16 v[112:127], v[8:11], v[24:27], v[112:127]
    ds_read_b128 v[32:35], v41 offset:0
    ds_read_b128 v[36:39], v41 offset:4096
    v_mfma_f32_32x32x16_bf16 v[192:207], v[8:11], v[28:31], v[192:207]
    ds_read_b64_tr_b16 v[8:9], v46 offset:32
    ds_read_b64_tr_b16 v[10:11], v46 offset:1312
    s_waitcnt lgkmcnt(10)
    v_mfma_f32_16x16x32_bf16 v[72:75], v[48:51], v[12:15], v[72:75]
    v_mfma_f32_32x32x16_bf16 v[128:143], v[12:15], v[24:27], v[128:143]
    v_add_u32 v44, s22, v44
    v_mfma_f32_32x32x16_bf16 v[208:223], v[12:15], v[28:31], v[208:223]
    ds_read_b64_tr_b16 v[12:13], v46 offset:64
    ds_read_b64_tr_b16 v[14:15], v46 offset:1344
    s_waitcnt lgkmcnt(10)
    v_mfma_f32_32x32x16_bf16 v[144:159], v[16:19], v[24:27], v[144:159]
    v_mfma_f32_32x32x16_bf16 v[224:239], v[16:19], v[28:31], v[224:239]
    ds_read_b64_tr_b16 v[16:17], v46 offset:96
    ds_read_b64_tr_b16 v[18:19], v46 offset:1376
    s_waitcnt lgkmcnt(10)
    v_mfma_f32_16x16x32_bf16 v[80:83], v[48:51], v[20:23], v[80:83]
    v_mfma_f32_32x32x16_bf16 v[160:175], v[20:23], v[24:27], v[160:175]
    s_cmp_eq_u32 s25, 3
    s_cselect_b32 s25, 0, s25
    v_mfma_f32_32x32x16_bf16 v[240:255], v[20:23], v[28:31], v[240:255]
    ds_read_b64_tr_b16 v[20:21], v46 offset:128
    ds_read_b64_tr_b16 v[22:23], v46 offset:1408
    s_waitcnt lgkmcnt(8)
    v_mfma_f32_32x32x16_bf16 v[96:111], v[4:7], v[32:35], v[96:111]
    s_barrier
    v_mfma_f32_32x32x16_bf16 v[176:191], v[4:7], v[36:39], v[176:191]
    ds_read_b64_tr_b16 v[4:5], v44 offset:0
    ds_read_b64_tr_b16 v[6:7], v44 offset:1280
    s_waitcnt lgkmcnt(8)
    v_mfma_f32_16x16x32_bf16 v[68:71], v[48:51], v[8:11], v[68:71]
    v_mfma_f32_32x32x16_bf16 v[112:127], v[8:11], v[32:35], v[112:127]
    ds_read_b128 v[24:27], v42 offset:0
    ds_read_b128 v[28:31], v42 offset:4096
    v_mfma_f32_32x32x16_bf16 v[192:207], v[8:11], v[36:39], v[192:207]
    ds_read_b64_tr_b16 v[8:9], v44 offset:32
    ds_read_b64_tr_b16 v[10:11], v44 offset:1312
    s_waitcnt lgkmcnt(10)
    v_mfma_f32_32x32x16_bf16 v[128:143], v[12:15], v[32:35], v[128:143]
    v_add_u32 v46, s22, v46
    v_mfma_f32_32x32x16_bf16 v[208:223], v[12:15], v[36:39], v[208:223]
    ds_read_b64_tr_b16 v[12:13], v44 offset:64
    ds_read_b64_tr_b16 v[14:15], v44 offset:1344
    s_waitcnt lgkmcnt(10)
    v_mfma_f32_16x16x32_bf16 v[76:79], v[48:51], v[16:19], v[76:79]
    v_mfma_f32_32x32x16_bf16 v[144:159], v[16:19], v[32:35], v[144:159]
    v_add_u32 v40, s24, v40
    v_add_u32 v41, s24, v41
    s_add_u32 s23, s23, 1
    s_cmp_eq_u32 s23, 5
    v_mfma_f32_32x32x16_bf16 v[224:239], v[16:19], v[36:39], v[224:239]
    ds_read_b64_tr_b16 v[16:17], v44 offset:96
    ds_read_b64_tr_b16 v[18:19], v44 offset:1376
    s_waitcnt lgkmcnt(10)
    v_mfma_f32_32x32x16_bf16 v[160:175], v[20:23], v[32:35], v[160:175]
    s_cselect_b32 s22, s45, s44
    s_cselect_b32 s23, 0, s23
    v_mfma_f32_32x32x16_bf16 v[240:255], v[20:23], v[36:39], v[240:255]
    ds_read_b64_tr_b16 v[20:21], v44 offset:128
    ds_read_b64_tr_b16 v[22:23], v44 offset:1408
    s_waitcnt lgkmcnt(8)
    v_mfma_f32_16x16x32_bf16 v[64:67], v[48:51], v[4:7], v[64:67]
    v_mfma_f32_32x32x16_bf16 v[96:111], v[4:7], v[24:27], v[96:111]
    v_mfma_f32_32x32x16_bf16 v[176:191], v[4:7], v[28:31], v[176:191]
    ds_read_b64_tr_b16 v[4:5], v46 offset:0
    ds_read_b64_tr_b16 v[6:7], v46 offset:1280
    s_waitcnt lgkmcnt(8)
    v_mfma_f32_32x32x16_bf16 v[112:127], v[8:11], v[24:27], v[112:127]
    ds_read_b128 v[32:35], v43 offset:0
    ds_read_b128 v[36:39], v43 offset:4096
    v_mfma_f32_32x32x16_bf16 v[192:207], v[8:11], v[28:31], v[192:207]
    ds_read_b64_tr_b16 v[8:9], v46 offset:32
    ds_read_b64_tr_b16 v[10:11], v46 offset:1312
    s_waitcnt lgkmcnt(10)
    v_mfma_f32_16x16x32_bf16 v[72:75], v[48:51], v[12:15], v[72:75]
    v_mfma_f32_32x32x16_bf16 v[128:143], v[12:15], v[24:27], v[128:143]
    v_add_u32 v44, s22, v44
    v_mfma_f32_32x32x16_bf16 v[208:223], v[12:15], v[28:31], v[208:223]
    ds_read_b64_tr_b16 v[12:13], v46 offset:64
    ds_read_b64_tr_b16 v[14:15], v46 offset:1344
    s_waitcnt lgkmcnt(10)
    v_mfma_f32_32x32x16_bf16 v[144:159], v[16:19], v[24:27], v[144:159]
    v_add_u32 v42, s24, v42
    v_mfma_f32_32x32x16_bf16 v[224:239], v[16:19], v[28:31], v[224:239]
    ds_read_b64_tr_b16 v[16:17], v46 offset:96
    ds_read_b64_tr_b16 v[18:19], v46 offset:1376
    s_waitcnt lgkmcnt(10)
    v_mfma_f32_16x16x32_bf16 v[80:83], v[48:51], v[20:23], v[80:83]
    v_mfma_f32_32x32x16_bf16 v[160:175], v[20:23], v[24:27], v[160:175]
    s_add_u32 s26, s26, 1
    v_mfma_f32_32x32x16_bf16 v[240:255], v[20:23], v[28:31], v[240:255]
    ds_read_b64_tr_b16 v[20:21], v46 offset:128
    ds_read_b64_tr_b16 v[22:23], v46 offset:1408
    s_waitcnt lgkmcnt(8)
    v_mfma_f32_32x32x16_bf16 v[96:111], v[4:7], v[32:35], v[96:111]
    s_barrier
    v_mfma_f32_32x32x16_bf16 v[176:191], v[4:7], v[36:39], v[176:191]
    ds_read_b64_tr_b16 v[4:5], v44 offset:0
    ds_read_b64_tr_b16 v[6:7], v44 offset:1280
    s_waitcnt lgkmcnt(8)
    v_mfma_f32_16x16x32_bf16 v[68:71], v[48:51], v[8:11], v[68:71]
    v_mfma_f32_32x32x16_bf16 v[112:127], v[8:11], v[32:35], v[112:127]
    ds_read_b128 v[24:27], v40 offset:0
    ds_read_b128 v[28:31], v40 offset:4096
    v_mfma_f32_32x32x16_bf16 v[192:207], v[8:11], v[36:39], v[192:207]
    ds_read_b64_tr_b16 v[8:9], v44 offset:32
    ds_read_b64_tr_b16 v[10:11], v44 offset:1312
    s_waitcnt lgkmcnt(10)
    v_mfma_f32_32x32x16_bf16 v[128:143], v[12:15], v[32:35], v[128:143]
    v_add_u32 v46, s22, v46
    v_mfma_f32_32x32x16_bf16 v[208:223], v[12:15], v[36:39], v[208:223]
    ds_read_b64_tr_b16 v[12:13], v44 offset:64
    ds_read_b64_tr_b16 v[14:15], v44 offset:1344
    s_waitcnt lgkmcnt(10)
    v_mfma_f32_16x16x32_bf16 v[76:79], v[48:51], v[16:19], v[76:79]
    v_mfma_f32_32x32x16_bf16 v[144:159], v[16:19], v[32:35], v[144:159]
    v_add_u32 v43, s24, v43
    s_add_u32 s23, s23, 1
    s_cmp_eq_u32 s23, 5
    v_mfma_f32_32x32x16_bf16 v[224:239], v[16:19], v[36:39], v[224:239]
    ds_read_b64_tr_b16 v[16:17], v44 offset:96
    ds_read_b64_tr_b16 v[18:19], v44 offset:1376
    s_waitcnt lgkmcnt(10)
    v_mfma_f32_32x32x16_bf16 v[160:175], v[20:23], v[32:35], v[160:175]
    s_cselect_b32 s22, s45, s44
    s_cselect_b32 s23, 0, s23
    s_cmp_lt_u32 s26, 10
    v_mfma_f32_32x32x16_bf16 v[240:255], v[20:23], v[36:39], v[240:255]
    ds_read_b64_tr_b16 v[20:21], v44 offset:128
    ds_read_b64_tr_b16 v[22:23], v44 offset:1408
    s_cbranch_scc1 K1_FFN_LOOP
    s_nop 7
    s_mov_b64 exec, 0xffff
    ds_write_b32 v62, v64 offset:0
    ds_write_b32 v62, v65 offset:640
    ds_write_b32 v62, v68 offset:64
    ds_write_b32 v62, v69 offset:704
    ds_write_b32 v62, v72 offset:128
    ds_write_b32 v62, v73 offset:768
    ds_write_b32 v62, v76 offset:192
    ds_write_b32 v62, v77 offset:832
    ds_write_b32 v62, v80 offset:256
    ds_write_b32 v62, v81 offset:896
    s_mov_b64 exec, -1
    s_waitcnt lgkmcnt(0)
    s_barrier
    ds_read_b64 v[64:65], v63 offset:0
    ds_read_b64 v[66:67], v63 offset:256
    s_barrier
    v_lshrrev_b32 v58, 5, v0
    v_lshlrev_b32 v58, 4, v58
    s_mul_i32 s27, s20, 320
    s_add_u32 s27, s27, 151872
    v_add_u32 v58, s27, v58
    ds_read_b128 v[4:7], v58 offset:0
    ds_read_b128 v[12:15], v58 offset:640
    ds_read_b128 v[8:11], v58 offset:32
    ds_read_b128 v[16:19], v58 offset:672
    s_add_u32 s4, s34, 10485760
    s_addc_u32 s5, s35, 0
    s_cmp_eq_u32 s18, 15
    s_cselect_b32 s27, 1, 0
    s_cmp_eq_u32 s20, 0
    s_cselect_b32 s27, s27, 0
    s_cmp_eq_u32 s27, 1
    s_cselect_b32 s6, 0, 6291456
    s_mov_b32 s7, 0x00020000
    s_sub_u32 s27, s18, 6
    s_mul_i32 s27, s27, 10
    s_min_u32 s27, s27, 86
    s_mul_i32 s30, s20, 5
    s_add_u32 s27, s27, s30
    s_lshl_b32 s30, s27, 10
    s_lshl_b32 s31, s17, 2
    s_lshl_b32 s27, s19, 1
    s_add_u32 s31, s31, s27
    s_mul_i32 s31, s31, 98304
    s_add_u32 s30, s30, s31
    v_lshlrev_b32 v71, 4, v0
    s_waitcnt lgkmcnt(4)
    v_mul_f32 v72, v65, v65
    v_rcp_f32 v72, v72
    v_mul_f32 v65, 0xbfb8aa3b, v65
    v_mul_f32 v74, v67, v67
    v_rcp_f32 v74, v74
    v_mul_f32 v67, 0xbfb8aa3b, v67
    ds_read_b128 v[20:23], v58 offset:64
    ds_read_b128 v[28:31], v58 offset:704
    ds_read_b128 v[24:27], v58 offset:96
    ds_read_b128 v[32:35], v58 offset:736
    s_waitcnt lgkmcnt(4)
    v_pk_fma_f32 v[96:97], v[4:5], v[64:65], v[96:97] op_sel:[0,0,0] op_sel_hi:[1,0,1]
    v_pk_fma_f32 v[98:99], v[6:7], v[64:65], v[98:99] op_sel:[0,0,0] op_sel_hi:[1,0,1]
    v_pk_fma_f32 v[100:101], v[8:9], v[64:65], v[100:101] op_sel:[0,0,0] op_sel_hi:[1,0,1]
    v_pk_fma_f32 v[102:103], v[10:11], v[64:65], v[102:103] op_sel:[0,0,0] op_sel_hi:[1,0,1]
    v_pk_fma_f32 v[176:177], v[4:5], v[66:67], v[176:177] op_sel:[0,0,0] op_sel_hi:[1,0,1]
    v_pk_fma_f32 v[178:179], v[6:7], v[66:67], v[178:179] op_sel:[0,0,0] op_sel_hi:[1,0,1]
    v_pk_fma_f32 v[180:181], v[8:9], v[66:67], v[180:181] op_sel:[0,0,0] op_sel_hi:[1,0,1]
    v_pk_fma_f32 v[182:183], v[10:11], v[66:67], v[182:183] op_sel:[0,0,0] op_sel_hi:[1,0,1]
    v_pk_mul_f32 v[76:77], v[96:97], v[64:65] op_sel:[0,1] op_sel_hi:[1,1]
    v_pk_mul_f32 v[78:79], v[98:99], v[64:65] op_sel:[0,1] op_sel_hi:[1,1]
    v_pk_mul_f32 v[80:81], v[100:101], v[64:65] op_sel:[0,1] op_sel_hi:[1,1]
    v_pk_mul_f32 v[82:83], v[102:103], v[64:65] op_sel:[0,1] op_sel_hi:[1,1]
    v_pk_mul_f32 v[84:85], v[176:177], v[66:67] op_sel:[0,1] op_sel_hi:[1,1]
    v_pk_mul_f32 v[86:87], v[178:179], v[66:67] op_sel:[0,1] op_sel_hi:[1,1]
    v_pk_mul_f32 v[88:89], v[180:181], v[66:67] op_sel:[0,1] op_sel_hi:[1,1]
    v_pk_mul_f32 v[90:91], v[182:183], v[66:67] op_sel:[0,1] op_sel_hi:[1,1]
    v_exp_f32 v76, v76
    v_exp_f32 v77, v77
    v_pk_fma_f32 v[104:105], v[12:13], v[64:65], v[104:105] op_sel:[0,0,0] op_sel_hi:[1,0,1]
    v_exp_f32 v78, v78
    v_exp_f32 v79, v79
    v_pk_fma_f32 v[106:107], v[14:15], v[64:65], v[106:107] op_sel:[0,0,0] op_sel_hi:[1,0,1]
    v_exp_f32 v80, v80
    v_exp_f32 v81, v81
    v_pk_fma_f32 v[108:109], v[16:17], v[64:65], v[108:109] op_sel:[0,0,0] op_sel_hi:[1,0,1]
    v_exp_f32 v82, v82
    v_exp_f32 v83, v83
    v_pk_fma_f32 v[110:111], v[18:19], v[64:65], v[110:111] op_sel:[0,0,0] op_sel_hi:[1,0,1]
    v_exp_f32 v84, v84
    v_exp_f32 v85, v85
    v_pk_fma_f32 v[184:185], v[12:13], v[66:67], v[184:185] op_sel:[0,0,0] op_sel_hi:[1,0,1]
    v_exp_f32 v86, v86
    v_exp_f32 v87, v87
    v_pk_fma_f32 v[186:187], v[14:15], v[66:67], v[186:187] op_sel:[0,0,0] op_sel_hi:[1,0,1]
    v_exp_f32 v88, v88
    v_exp_f32 v89, v89
    v_pk_fma_f32 v[188:189], v[16:17], v[66:67], v[188:189] op_sel:[0,0,0] op_sel_hi:[1,0,1]
    v_exp_f32 v90, v90
    v_exp_f32 v91, v91
    v_pk_fma_f32 v[190:191], v[18:19], v[66:67], v[190:191] op_sel:[0,0,0] op_sel_hi:[1,0,1]
    v_pk_fma_f32 v[76:77], v[76:77], v[72:73], v[72:73] op_sel:[0,0,0] op_sel_hi:[1,0,0]
    v_pk_mul_f32 v[96:97], v[96:97], v[104:105] op_sel:[0,0] op_sel_hi:[1,1]
    v_pk_fma_f32 v[78:79], v[78:79], v[72:73], v[72:73] op_sel:[0,0,0] op_sel_hi:[1,0,0]
    v_pk_mul_f32 v[98:99], v[98:99], v[106:107] op_sel:[0,0] op_sel_hi:[1,1]
    v_pk_fma_f32 v[80:81], v[80:81], v[72:73], v[72:73] op_sel:[0,0,0] op_sel_hi:[1,0,0]
    v_pk_mul_f32 v[100:101], v[100:101], v[108:109] op_sel:[0,0] op_sel_hi:[1,1]
    v_pk_fma_f32 v[82:83], v[82:83], v[72:73], v[72:73] op_sel:[0,0,0] op_sel_hi:[1,0,0]
    v_pk_mul_f32 v[102:103], v[102:103], v[110:111] op_sel:[0,0] op_sel_hi:[1,1]
    v_pk_fma_f32 v[84:85], v[84:85], v[74:75], v[74:75] op_sel:[0,0,0] op_sel_hi:[1,0,0]
    v_pk_mul_f32 v[176:177], v[176:177], v[184:185] op_sel:[0,0] op_sel_hi:[1,1]
    v_pk_fma_f32 v[86:87], v[86:87], v[74:75], v[74:75] op_sel:[0,0,0] op_sel_hi:[1,0,0]
    v_pk_mul_f32 v[178:179], v[178:179], v[186:187] op_sel:[0,0] op_sel_hi:[1,1]
    v_pk_fma_f32 v[88:89], v[88:89], v[74:75], v[74:75] op_sel:[0,0,0] op_sel_hi:[1,0,0]
    v_pk_mul_f32 v[180:181], v[180:181], v[188:189] op_sel:[0,0] op_sel_hi:[1,1]
    v_pk_fma_f32 v[90:91], v[90:91], v[74:75], v[74:75] op_sel:[0,0,0] op_sel_hi:[1,0,0]
    v_pk_mul_f32 v[182:183], v[182:183], v[190:191] op_sel:[0,0] op_sel_hi:[1,1]
    v_rcp_f32 v76, v76
    v_rcp_f32 v77, v77
    v_rcp_f32 v78, v78
    v_rcp_f32 v79, v79
    v_rcp_f32 v80, v80
    v_rcp_f32 v81, v81
    v_rcp_f32 v82, v82
    v_rcp_f32 v83, v83
    v_rcp_f32 v84, v84
    v_rcp_f32 v85, v85
    v_rcp_f32 v86, v86
    v_rcp_f32 v87, v87
    v_rcp_f32 v88, v88
    v_rcp_f32 v89, v89
    v_rcp_f32 v90, v90
    v_rcp_f32 v91, v91
    v_pk_mul_f32 v[96:97], v[96:97], v[76:77] op_sel:[0,0] op_sel_hi:[1,1]
    v_pk_mul_f32 v[98:99], v[98:99], v[78:79] op_sel:[0,0] op_sel_hi:[1,1]
    v_pk_mul_f32 v[100:101], v[100:101], v[80:81] op_sel:[0,0] op_sel_hi:[1,1]
    v_pk_mul_f32 v[102:103], v[102:103], v[82:83] op_sel:[0,0] op_sel_hi:[1,1]
    v_pk_mul_f32 v[176:177], v[176:177], v[84:85] op_sel:[0,0] op_sel_hi:[1,1]
    v_pk_mul_f32 v[178:179], v[178:179], v[86:87] op_sel:[0,0] op_sel_hi:[1,1]
    v_pk_mul_f32 v[180:181], v[180:181], v[88:89] op_sel:[0,0] op_sel_hi:[1,1]
    v_pk_mul_f32 v[182:183], v[182:183], v[90:91] op_sel:[0,0] op_sel_hi:[1,1]
    v_cvt_pk_bf16_f32 v104, v96, v97
    v_cvt_pk_bf16_f32 v105, v98, v99
    v_cvt_pk_bf16_f32 v106, v100, v101
    v_cvt_pk_bf16_f32 v107, v102, v103
    s_add_u32 s27, s30, 0
    buffer_store_dwordx4 v[104:107], v71, s[4:7], s27 offen sc1
    v_cvt_pk_bf16_f32 v184, v176, v177
    v_cvt_pk_bf16_f32 v185, v178, v179
    v_cvt_pk_bf16_f32 v186, v180, v181
    v_cvt_pk_bf16_f32 v187, v182, v183
    s_add_u32 s27, s30, 98304
    buffer_store_dwordx4 v[184:187], v71, s[4:7], s27 offen sc1
    ds_read_b128 v[4:7], v58 offset:128
    ds_read_b128 v[12:15], v58 offset:768
    ds_read_b128 v[8:11], v58 offset:160
    ds_read_b128 v[16:19], v58 offset:800
    s_waitcnt lgkmcnt(4)
    v_pk_fma_f32 v[112:113], v[20:21], v[64:65], v[112:113] op_sel:[0,0,0] op_sel_hi:[1,0,1]
    v_pk_fma_f32 v[114:115], v[22:23], v[64:65], v[114:115] op_sel:[0,0,0] op_sel_hi:[1,0,1]
    v_pk_fma_f32 v[116:117], v[24:25], v[64:65], v[116:117] op_sel:[0,0,0] op_sel_hi:[1,0,1]
    v_pk_fma_f32 v[118:119], v[26:27], v[64:65], v[118:119] op_sel:[0,0,0] op_sel_hi:[1,0,1]
    v_pk_fma_f32 v[192:193], v[20:21], v[66:67], v[192:193] op_sel:[0,0,0] op_sel_hi:[1,0,1]
    v_pk_fma_f32 v[194:195], v[22:23], v[66:67], v[194:195] op_sel:[0,0,0] op_sel_hi:[1,0,1]
    v_pk_fma_f32 v[196:197], v[24:25], v[66:67], v[196:197] op_sel:[0,0,0] op_sel_hi:[1,0,1]
    v_pk_fma_f32 v[198:199], v[26:27], v[66:67], v[198:199] op_sel:[0,0,0] op_sel_hi:[1,0,1]
    v_pk_mul_f32 v[76:77], v[112:113], v[64:65] op_sel:[0,1] op_sel_hi:[1,1]
    v_pk_mul_f32 v[78:79], v[114:115], v[64:65] op_sel:[0,1] op_sel_hi:[1,1]
    v_pk_mul_f32 v[80:81], v[116:117], v[64:65] op_sel:[0,1] op_sel_hi:[1,1]
    v_pk_mul_f32 v[82:83], v[118:119], v[64:65] op_sel:[0,1] op_sel_hi:[1,1]
    v_pk_mul_f32 v[84:85], v[192:193], v[66:67] op_sel:[0,1] op_sel_hi:[1,1]
    v_pk_mul_f32 v[86:87], v[194:195], v[66:67] op_sel:[0,1] op_sel_hi:[1,1]
    v_pk_mul_f32 v[88:89], v[196:197], v[66:67] op_sel:[0,1] op_sel_hi:[1,1]
    v_pk_mul_f32 v[90:91], v[198:199], v[66:67] op_sel:[0,1] op_sel_hi:[1,1]
    v_exp_f32 v76, v76
    v_exp_f32 v77, v77
    v_pk_fma_f32 v[120:121], v[28:29], v[64:65], v[120:121] op_sel:[0,0,0] op_sel_hi:[1,0,1]
    v_exp_f32 v78, v78
    v_exp_f32 v79, v79
    v_pk_fma_f32 v[122:123], v[30:31], v[64:65], v[122:123] op_sel:[0,0,0] op_sel_hi:[1,0,1]
    v_exp_f32 v80, v80
    v_exp_f32 v81, v81
    v_pk_fma_f32 v[124:125], v[32:33], v[64:65], v[124:125] op_sel:[0,0,0] op_sel_hi:[1,0,1]
    v_exp_f32 v82, v82
    v_exp_f32 v83, v83
    v_pk_fma_f32 v[126:127], v[34:35], v[64:65], v[126:127] op_sel:[0,0,0] op_sel_hi:[1,0,1]
    v_exp_f32 v84, v84
    v_exp_f32 v85, v85
    v_pk_fma_f32 v[200:201], v[28:29], v[66:67], v[200:201] op_sel:[0,0,0] op_sel_hi:[1,0,1]
    v_exp_f32 v86, v86
    v_exp_f32 v87, v87
    v_pk_fma_f32 v[202:203], v[30:31], v[66:67], v[202:203] op_sel:[0,0,0] op_sel_hi:[1,0,1]
    v_exp_f32 v88, v88
    v_exp_f32 v89, v89
    v_pk_fma_f32 v[204:205], v[32:33], v[66:67], v[204:205] op_sel:[0,0,0] op_sel_hi:[1,0,1]
    v_exp_f32 v90, v90
    v_exp_f32 v91, v91
    v_pk_fma_f32 v[206:207], v[34:35], v[66:67], v[206:207] op_sel:[0,0,0] op_sel_hi:[1,0,1]
    v_pk_fma_f32 v[76:77], v[76:77], v[72:73], v[72:73] op_sel:[0,0,0] op_sel_hi:[1,0,0]
    v_pk_mul_f32 v[112:113], v[112:113], v[120:121] op_sel:[0,0] op_sel_hi:[1,1]
    v_pk_fma_f32 v[78:79], v[78:79], v[72:73], v[72:73] op_sel:[0,0,0] op_sel_hi:[1,0,0]
    v_pk_mul_f32 v[114:115], v[114:115], v[122:123] op_sel:[0,0] op_sel_hi:[1,1]
    v_pk_fma_f32 v[80:81], v[80:81], v[72:73], v[72:73] op_sel:[0,0,0] op_sel_hi:[1,0,0]
    v_pk_mul_f32 v[116:117], v[116:117], v[124:125] op_sel:[0,0] op_sel_hi:[1,1]
    v_pk_fma_f32 v[82:83], v[82:83], v[72:73], v[72:73] op_sel:[0,0,0] op_sel_hi:[1,0,0]
    v_pk_mul_f32 v[118:119], v[118:119], v[126:127] op_sel:[0,0] op_sel_hi:[1,1]
    v_pk_fma_f32 v[84:85], v[84:85], v[74:75], v[74:75] op_sel:[0,0,0] op_sel_hi:[1,0,0]
    v_pk_mul_f32 v[192:193], v[192:193], v[200:201] op_sel:[0,0] op_sel_hi:[1,1]
    v_pk_fma_f32 v[86:87], v[86:87], v[74:75], v[74:75] op_sel:[0,0,0] op_sel_hi:[1,0,0]
    v_pk_mul_f32 v[194:195], v[194:195], v[202:203] op_sel:[0,0] op_sel_hi:[1,1]
    v_pk_fma_f32 v[88:89], v[88:89], v[74:75], v[74:75] op_sel:[0,0,0] op_sel_hi:[1,0,0]
    v_pk_mul_f32 v[196:197], v[196:197], v[204:205] op_sel:[0,0] op_sel_hi:[1,1]
    v_pk_fma_f32 v[90:91], v[90:91], v[74:75], v[74:75] op_sel:[0,0,0] op_sel_hi:[1,0,0]
    v_pk_mul_f32 v[198:199], v[198:199], v[206:207] op_sel:[0,0] op_sel_hi:[1,1]
    v_rcp_f32 v76, v76
    v_rcp_f32 v77, v77
    v_rcp_f32 v78, v78
    v_rcp_f32 v79, v79
    v_rcp_f32 v80, v80
    v_rcp_f32 v81, v81
    v_rcp_f32 v82, v82
    v_rcp_f32 v83, v83
    v_rcp_f32 v84, v84
    v_rcp_f32 v85, v85
    v_rcp_f32 v86, v86
    v_rcp_f32 v87, v87
    v_rcp_f32 v88, v88
    v_rcp_f32 v89, v89
    v_rcp_f32 v90, v90
    v_rcp_f32 v91, v91
    v_pk_mul_f32 v[112:113], v[112:113], v[76:77] op_sel:[0,0] op_sel_hi:[1,1]
    v_pk_mul_f32 v[114:115], v[114:115], v[78:79] op_sel:[0,0] op_sel_hi:[1,1]
    v_pk_mul_f32 v[116:117], v[116:117], v[80:81] op_sel:[0,0] op_sel_hi:[1,1]
    v_pk_mul_f32 v[118:119], v[118:119], v[82:83] op_sel:[0,0] op_sel_hi:[1,1]
    v_pk_mul_f32 v[192:193], v[192:193], v[84:85] op_sel:[0,0] op_sel_hi:[1,1]
    v_pk_mul_f32 v[194:195], v[194:195], v[86:87] op_sel:[0,0] op_sel_hi:[1,1]
    v_pk_mul_f32 v[196:197], v[196:197], v[88:89] op_sel:[0,0] op_sel_hi:[1,1]
    v_pk_mul_f32 v[198:199], v[198:199], v[90:91] op_sel:[0,0] op_sel_hi:[1,1]
    v_cvt_pk_bf16_f32 v120, v112, v113
    v_cvt_pk_bf16_f32 v121, v114, v115
    v_cvt_pk_bf16_f32 v122, v116, v117
    v_cvt_pk_bf16_f32 v123, v118, v119
    s_add_u32 s27, s30, 1024
    buffer_store_dwordx4 v[120:123], v71, s[4:7], s27 offen sc1
    v_cvt_pk_bf16_f32 v200, v192, v193
    v_cvt_pk_bf16_f32 v201, v194, v195
    v_cvt_pk_bf16_f32 v202, v196, v197
    v_cvt_pk_bf16_f32 v203, v198, v199
    s_add_u32 s27, s30, 99328
    buffer_store_dwordx4 v[200:203], v71, s[4:7], s27 offen sc1
    ds_read_b128 v[20:23], v58 offset:192
    ds_read_b128 v[28:31], v58 offset:832
    ds_read_b128 v[24:27], v58 offset:224
    ds_read_b128 v[32:35], v58 offset:864
    s_waitcnt lgkmcnt(4)
    v_pk_fma_f32 v[128:129], v[4:5], v[64:65], v[128:129] op_sel:[0,0,0] op_sel_hi:[1,0,1]
    v_pk_fma_f32 v[130:131], v[6:7], v[64:65], v[130:131] op_sel:[0,0,0] op_sel_hi:[1,0,1]
    v_pk_fma_f32 v[132:133], v[8:9], v[64:65], v[132:133] op_sel:[0,0,0] op_sel_hi:[1,0,1]
    v_pk_fma_f32 v[134:135], v[10:11], v[64:65], v[134:135] op_sel:[0,0,0] op_sel_hi:[1,0,1]
    v_pk_fma_f32 v[208:209], v[4:5], v[66:67], v[208:209] op_sel:[0,0,0] op_sel_hi:[1,0,1]
    v_pk_fma_f32 v[210:211], v[6:7], v[66:67], v[210:211] op_sel:[0,0,0] op_sel_hi:[1,0,1]
    v_pk_fma_f32 v[212:213], v[8:9], v[66:67], v[212:213] op_sel:[0,0,0] op_sel_hi:[1,0,1]
    v_pk_fma_f32 v[214:215], v[10:11], v[66:67], v[214:215] op_sel:[0,0,0] op_sel_hi:[1,0,1]
    v_pk_mul_f32 v[76:77], v[128:129], v[64:65] op_sel:[0,1] op_sel_hi:[1,1]
    v_pk_mul_f32 v[78:79], v[130:131], v[64:65] op_sel:[0,1] op_sel_hi:[1,1]
    v_pk_mul_f32 v[80:81], v[132:133], v[64:65] op_sel:[0,1] op_sel_hi:[1,1]
    v_pk_mul_f32 v[82:83], v[134:135], v[64:65] op_sel:[0,1] op_sel_hi:[1,1]
    v_pk_mul_f32 v[84:85], v[208:209], v[66:67] op_sel:[0,1] op_sel_hi:[1,1]
    v_pk_mul_f32 v[86:87], v[210:211], v[66:67] op_sel:[0,1] op_sel_hi:[1,1]
    v_pk_mul_f32 v[88:89], v[212:213], v[66:67] op_sel:[0,1] op_sel_hi:[1,1]
    v_pk_mul_f32 v[90:91], v[214:215], v[66:67] op_sel:[0,1] op_sel_hi:[1,1]
    v_exp_f32 v76, v76
    v_exp_f32 v77, v77
    v_pk_fma_f32 v[136:137], v[12:13], v[64:65], v[136:137] op_sel:[0,0,0] op_sel_hi:[1,0,1]
    v_exp_f32 v78, v78
    v_exp_f32 v79, v79
    v_pk_fma_f32 v[138:139], v[14:15], v[64:65], v[138:139] op_sel:[0,0,0] op_sel_hi:[1,0,1]
    v_exp_f32 v80, v80
    v_exp_f32 v81, v81
    v_pk_fma_f32 v[140:141], v[16:17], v[64:65], v[140:141] op_sel:[0,0,0] op_sel_hi:[1,0,1]
    v_exp_f32 v82, v82
    v_exp_f32 v83, v83
    v_pk_fma_f32 v[142:143], v[18:19], v[64:65], v[142:143] op_sel:[0,0,0] op_sel_hi:[1,0,1]
    v_exp_f32 v84, v84
    v_exp_f32 v85, v85
    v_pk_fma_f32 v[216:217], v[12:13], v[66:67], v[216:217] op_sel:[0,0,0] op_sel_hi:[1,0,1]
    v_exp_f32 v86, v86
    v_exp_f32 v87, v87
    v_pk_fma_f32 v[218:219], v[14:15], v[66:67], v[218:219] op_sel:[0,0,0] op_sel_hi:[1,0,1]
    v_exp_f32 v88, v88
    v_exp_f32 v89, v89
    v_pk_fma_f32 v[220:221], v[16:17], v[66:67], v[220:221] op_sel:[0,0,0] op_sel_hi:[1,0,1]
    v_exp_f32 v90, v90
    v_exp_f32 v91, v91
    v_pk_fma_f32 v[222:223], v[18:19], v[66:67], v[222:223] op_sel:[0,0,0] op_sel_hi:[1,0,1]
    v_pk_fma_f32 v[76:77], v[76:77], v[72:73], v[72:73] op_sel:[0,0,0] op_sel_hi:[1,0,0]
    v_pk_mul_f32 v[128:129], v[128:129], v[136:137] op_sel:[0,0] op_sel_hi:[1,1]
    v_pk_fma_f32 v[78:79], v[78:79], v[72:73], v[72:73] op_sel:[0,0,0] op_sel_hi:[1,0,0]
    v_pk_mul_f32 v[130:131], v[130:131], v[138:139] op_sel:[0,0] op_sel_hi:[1,1]
    v_pk_fma_f32 v[80:81], v[80:81], v[72:73], v[72:73] op_sel:[0,0,0] op_sel_hi:[1,0,0]
    v_pk_mul_f32 v[132:133], v[132:133], v[140:141] op_sel:[0,0] op_sel_hi:[1,1]
    v_pk_fma_f32 v[82:83], v[82:83], v[72:73], v[72:73] op_sel:[0,0,0] op_sel_hi:[1,0,0]
    v_pk_mul_f32 v[134:135], v[134:135], v[142:143] op_sel:[0,0] op_sel_hi:[1,1]
    v_pk_fma_f32 v[84:85], v[84:85], v[74:75], v[74:75] op_sel:[0,0,0] op_sel_hi:[1,0,0]
    v_pk_mul_f32 v[208:209], v[208:209], v[216:217] op_sel:[0,0] op_sel_hi:[1,1]
    v_pk_fma_f32 v[86:87], v[86:87], v[74:75], v[74:75] op_sel:[0,0,0] op_sel_hi:[1,0,0]
    v_pk_mul_f32 v[210:211], v[210:211], v[218:219] op_sel:[0,0] op_sel_hi:[1,1]
    v_pk_fma_f32 v[88:89], v[88:89], v[74:75], v[74:75] op_sel:[0,0,0] op_sel_hi:[1,0,0]
    v_pk_mul_f32 v[212:213], v[212:213], v[220:221] op_sel:[0,0] op_sel_hi:[1,1]
    v_pk_fma_f32 v[90:91], v[90:91], v[74:75], v[74:75] op_sel:[0,0,0] op_sel_hi:[1,0,0]
    v_pk_mul_f32 v[214:215], v[214:215], v[222:223] op_sel:[0,0] op_sel_hi:[1,1]
    v_rcp_f32 v76, v76
    v_rcp_f32 v77, v77
    v_rcp_f32 v78, v78
    v_rcp_f32 v79, v79
    v_rcp_f32 v80, v80
    v_rcp_f32 v81, v81
    v_rcp_f32 v82, v82
    v_rcp_f32 v83, v83
    v_rcp_f32 v84, v84
    v_rcp_f32 v85, v85
    v_rcp_f32 v86, v86
    v_rcp_f32 v87, v87
    v_rcp_f32 v88, v88
    v_rcp_f32 v89, v89
    v_rcp_f32 v90, v90
    v_rcp_f32 v91, v91
    v_pk_mul_f32 v[128:129], v[128:129], v[76:77] op_sel:[0,0] op_sel_hi:[1,1]
    v_pk_mul_f32 v[130:131], v[130:131], v[78:79] op_sel:[0,0] op_sel_hi:[1,1]
    v_pk_mul_f32 v[132:133], v[132:133], v[80:81] op_sel:[0,0] op_sel_hi:[1,1]
    v_pk_mul_f32 v[134:135], v[134:135], v[82:83] op_sel:[0,0] op_sel_hi:[1,1]
    v_pk_mul_f32 v[208:209], v[208:209], v[84:85] op_sel:[0,0] op_sel_hi:[1,1]
    v_pk_mul_f32 v[210:211], v[210:211], v[86:87] op_sel:[0,0] op_sel_hi:[1,1]
    v_pk_mul_f32 v[212:213], v[212:213], v[88:89] op_sel:[0,0] op_sel_hi:[1,1]
    v_pk_mul_f32 v[214:215], v[214:215], v[90:91] op_sel:[0,0] op_sel_hi:[1,1]
    v_cvt_pk_bf16_f32 v136, v128, v129
    v_cvt_pk_bf16_f32 v137, v130, v131
    v_cvt_pk_bf16_f32 v138, v132, v133
    v_cvt_pk_bf16_f32 v139, v134, v135
    s_add_u32 s27, s30, 2048
    buffer_store_dwordx4 v[136:139], v71, s[4:7], s27 offen sc1
    v_cvt_pk_bf16_f32 v216, v208, v209
    v_cvt_pk_bf16_f32 v217, v210, v211
    v_cvt_pk_bf16_f32 v218, v212, v213
    v_cvt_pk_bf16_f32 v219, v214, v215
    s_add_u32 s27, s30, 100352
    buffer_store_dwordx4 v[216:219], v71, s[4:7], s27 offen sc1
    ds_read_b128 v[4:7], v58 offset:256
    ds_read_b128 v[12:15], v58 offset:896
    ds_read_b128 v[8:11], v58 offset:288
    ds_read_b128 v[16:19], v58 offset:928
    s_waitcnt lgkmcnt(4)
    v_pk_fma_f32 v[144:145], v[20:21], v[64:65], v[144:145] op_sel:[0,0,0] op_sel_hi:[1,0,1]
    v_pk_fma_f32 v[146:147], v[22:23], v[64:65], v[146:147] op_sel:[0,0,0] op_sel_hi:[1,0,1]
    v_pk_fma_f32 v[148:149], v[24:25], v[64:65], v[148:149] op_sel:[0,0,0] op_sel_hi:[1,0,1]
    v_pk_fma_f32 v[150:151], v[26:27], v[64:65], v[150:151] op_sel:[0,0,0] op_sel_hi:[1,0,1]
    v_pk_fma_f32 v[224:225], v[20:21], v[66:67], v[224:225] op_sel:[0,0,0] op_sel_hi:[1,0,1]
    v_pk_fma_f32 v[226:227], v[22:23], v[66:67], v[226:227] op_sel:[0,0,0] op_sel_hi:[1,0,1]
    v_pk_fma_f32 v[228:229], v[24:25], v[66:67], v[228:229] op_sel:[0,0,0] op_sel_hi:[1,0,1]
    v_pk_fma_f32 v[230:231], v[26:27], v[66:67], v[230:231] op_sel:[0,0,0] op_sel_hi:[1,0,1]
    v_pk_mul_f32 v[76:77], v[144:145], v[64:65] op_sel:[0,1] op_sel_hi:[1,1]
    v_pk_mul_f32 v[78:79], v[146:147], v[64:65] op_sel:[0,1] op_sel_hi:[1,1]
    v_pk_mul_f32 v[80:81], v[148:149], v[64:65] op_sel:[0,1] op_sel_hi:[1,1]
    v_pk_mul_f32 v[82:83], v[150:151], v[64:65] op_sel:[0,1] op_sel_hi:[1,1]
    v_pk_mul_f32 v[84:85], v[224:225], v[66:67] op_sel:[0,1] op_sel_hi:[1,1]
    v_pk_mul_f32 v[86:87], v[226:227], v[66:67] op_sel:[0,1] op_sel_hi:[1,1]
    v_pk_mul_f32 v[88:89], v[228:229], v[66:67] op_sel:[0,1] op_sel_hi:[1,1]
    v_pk_mul_f32 v[90:91], v[230:231], v[66:67] op_sel:[0,1] op_sel_hi:[1,1]
    v_exp_f32 v76, v76
    v_exp_f32 v77, v77
    v_pk_fma_f32 v[152:153], v[28:29], v[64:65], v[152:153] op_sel:[0,0,0] op_sel_hi:[1,0,1]
    v_exp_f32 v78, v78
    v_exp_f32 v79, v79
    v_pk_fma_f32 v[154:155], v[30:31], v[64:65], v[154:155] op_sel:[0,0,0] op_sel_hi:[1,0,1]
    v_exp_f32 v80, v80
    v_exp_f32 v81, v81
    v_pk_fma_f32 v[156:157], v[32:33], v[64:65], v[156:157] op_sel:[0,0,0] op_sel_hi:[1,0,1]
    v_exp_f32 v82, v82
    v_exp_f32 v83, v83
    v_pk_fma_f32 v[158:159], v[34:35], v[64:65], v[158:159] op_sel:[0,0,0] op_sel_hi:[1,0,1]
    v_exp_f32 v84, v84
    v_exp_f32 v85, v85
    v_pk_fma_f32 v[232:233], v[28:29], v[66:67], v[232:233] op_sel:[0,0,0] op_sel_hi:[1,0,1]
    v_exp_f32 v86, v86
    v_exp_f32 v87, v87
    v_pk_fma_f32 v[234:235], v[30:31], v[66:67], v[234:235] op_sel:[0,0,0] op_sel_hi:[1,0,1]
    v_exp_f32 v88, v88
    v_exp_f32 v89, v89
    v_pk_fma_f32 v[236:237], v[32:33], v[66:67], v[236:237] op_sel:[0,0,0] op_sel_hi:[1,0,1]
    v_exp_f32 v90, v90
    v_exp_f32 v91, v91
    v_pk_fma_f32 v[238:239], v[34:35], v[66:67], v[238:239] op_sel:[0,0,0] op_sel_hi:[1,0,1]
    v_pk_fma_f32 v[76:77], v[76:77], v[72:73], v[72:73] op_sel:[0,0,0] op_sel_hi:[1,0,0]
    v_pk_mul_f32 v[144:145], v[144:145], v[152:153] op_sel:[0,0] op_sel_hi:[1,1]
    v_pk_fma_f32 v[78:79], v[78:79], v[72:73], v[72:73] op_sel:[0,0,0] op_sel_hi:[1,0,0]
    v_pk_mul_f32 v[146:147], v[146:147], v[154:155] op_sel:[0,0] op_sel_hi:[1,1]
    v_pk_fma_f32 v[80:81], v[80:81], v[72:73], v[72:73] op_sel:[0,0,0] op_sel_hi:[1,0,0]
    v_pk_mul_f32 v[148:149], v[148:149], v[156:157] op_sel:[0,0] op_sel_hi:[1,1]
    v_pk_fma_f32 v[82:83], v[82:83], v[72:73], v[72:73] op_sel:[0,0,0] op_sel_hi:[1,0,0]
    v_pk_mul_f32 v[150:151], v[150:151], v[158:159] op_sel:[0,0] op_sel_hi:[1,1]
    v_pk_fma_f32 v[84:85], v[84:85], v[74:75], v[74:75] op_sel:[0,0,0] op_sel_hi:[1,0,0]
    v_pk_mul_f32 v[224:225], v[224:225], v[232:233] op_sel:[0,0] op_sel_hi:[1,1]
    v_pk_fma_f32 v[86:87], v[86:87], v[74:75], v[74:75] op_sel:[0,0,0] op_sel_hi:[1,0,0]
    v_pk_mul_f32 v[226:227], v[226:227], v[234:235] op_sel:[0,0] op_sel_hi:[1,1]
    v_pk_fma_f32 v[88:89], v[88:89], v[74:75], v[74:75] op_sel:[0,0,0] op_sel_hi:[1,0,0]
    v_pk_mul_f32 v[228:229], v[228:229], v[236:237] op_sel:[0,0] op_sel_hi:[1,1]
    v_pk_fma_f32 v[90:91], v[90:91], v[74:75], v[74:75] op_sel:[0,0,0] op_sel_hi:[1,0,0]
    v_pk_mul_f32 v[230:231], v[230:231], v[238:239] op_sel:[0,0] op_sel_hi:[1,1]
    v_rcp_f32 v76, v76
    v_rcp_f32 v77, v77
    v_rcp_f32 v78, v78
    v_rcp_f32 v79, v79
    v_rcp_f32 v80, v80
    v_rcp_f32 v81, v81
    v_rcp_f32 v82, v82
    v_rcp_f32 v83, v83
    v_rcp_f32 v84, v84
    v_rcp_f32 v85, v85
    v_rcp_f32 v86, v86
    v_rcp_f32 v87, v87
    v_rcp_f32 v88, v88
    v_rcp_f32 v89, v89
    v_rcp_f32 v90, v90
    v_rcp_f32 v91, v91
    v_pk_mul_f32 v[144:145], v[144:145], v[76:77] op_sel:[0,0] op_sel_hi:[1,1]
    v_pk_mul_f32 v[146:147], v[146:147], v[78:79] op_sel:[0,0] op_sel_hi:[1,1]
    v_pk_mul_f32 v[148:149], v[148:149], v[80:81] op_sel:[0,0] op_sel_hi:[1,1]
    v_pk_mul_f32 v[150:151], v[150:151], v[82:83] op_sel:[0,0] op_sel_hi:[1,1]
    v_pk_mul_f32 v[224:225], v[224:225], v[84:85] op_sel:[0,0] op_sel_hi:[1,1]
    v_pk_mul_f32 v[226:227], v[226:227], v[86:87] op_sel:[0,0] op_sel_hi:[1,1]
    v_pk_mul_f32 v[228:229], v[228:229], v[88:89] op_sel:[0,0] op_sel_hi:[1,1]
    v_pk_mul_f32 v[230:231], v[230:231], v[90:91] op_sel:[0,0] op_sel_hi:[1,1]
    v_cvt_pk_bf16_f32 v152, v144, v145
    v_cvt_pk_bf16_f32 v153, v146, v147
    v_cvt_pk_bf16_f32 v154, v148, v149
    v_cvt_pk_bf16_f32 v155, v150, v151
    s_add_u32 s27, s30, 3072
    buffer_store_dwordx4 v[152:155], v71, s[4:7], s27 offen sc1
    v_cvt_pk_bf16_f32 v232, v224, v225
    v_cvt_pk_bf16_f32 v233, v226, v227
    v_cvt_pk_bf16_f32 v234, v228, v229
    v_cvt_pk_bf16_f32 v235, v230, v231
    s_add_u32 s27, s30, 101376
    buffer_store_dwordx4 v[232:235], v71, s[4:7], s27 offen sc1
    s_waitcnt lgkmcnt(0)
    v_pk_fma_f32 v[160:161], v[4:5], v[64:65], v[160:161] op_sel:[0,0,0] op_sel_hi:[1,0,1]
    v_pk_fma_f32 v[162:163], v[6:7], v[64:65], v[162:163] op_sel:[0,0,0] op_sel_hi:[1,0,1]
    v_pk_fma_f32 v[164:165], v[8:9], v[64:65], v[164:165] op_sel:[0,0,0] op_sel_hi:[1,0,1]
    v_pk_fma_f32 v[166:167], v[10:11], v[64:65], v[166:167] op_sel:[0,0,0] op_sel_hi:[1,0,1]
    v_pk_fma_f32 v[240:241], v[4:5], v[66:67], v[240:241] op_sel:[0,0,0] op_sel_hi:[1,0,1]
    v_pk_fma_f32 v[242:243], v[6:7], v[66:67], v[242:243] op_sel:[0,0,0] op_sel_hi:[1,0,1]
    v_pk_fma_f32 v[244:245], v[8:9], v[66:67], v[244:245] op_sel:[0,0,0] op_sel_hi:[1,0,1]
    v_pk_fma_f32 v[246:247], v[10:11], v[66:67], v[246:247] op_sel:[0,0,0] op_sel_hi:[1,0,1]
    v_pk_mul_f32 v[76:77], v[160:161], v[64:65] op_sel:[0,1] op_sel_hi:[1,1]
    v_pk_mul_f32 v[78:79], v[162:163], v[64:65] op_sel:[0,1] op_sel_hi:[1,1]
    v_pk_mul_f32 v[80:81], v[164:165], v[64:65] op_sel:[0,1] op_sel_hi:[1,1]
    v_pk_mul_f32 v[82:83], v[166:167], v[64:65] op_sel:[0,1] op_sel_hi:[1,1]
    v_pk_mul_f32 v[84:85], v[240:241], v[66:67] op_sel:[0,1] op_sel_hi:[1,1]
    v_pk_mul_f32 v[86:87], v[242:243], v[66:67] op_sel:[0,1] op_sel_hi:[1,1]
    v_pk_mul_f32 v[88:89], v[244:245], v[66:67] op_sel:[0,1] op_sel_hi:[1,1]
    v_pk_mul_f32 v[90:91], v[246:247], v[66:67] op_sel:[0,1] op_sel_hi:[1,1]
    v_exp_f32 v76, v76
    v_exp_f32 v77, v77
    v_pk_fma_f32 v[168:169], v[12:13], v[64:65], v[168:169] op_sel:[0,0,0] op_sel_hi:[1,0,1]
    v_exp_f32 v78, v78
    v_exp_f32 v79, v79
    v_pk_fma_f32 v[170:171], v[14:15], v[64:65], v[170:171] op_sel:[0,0,0] op_sel_hi:[1,0,1]
    v_exp_f32 v80, v80
    v_exp_f32 v81, v81
    v_pk_fma_f32 v[172:173], v[16:17], v[64:65], v[172:173] op_sel:[0,0,0] op_sel_hi:[1,0,1]
    v_exp_f32 v82, v82
    v_exp_f32 v83, v83
    v_pk_fma_f32 v[174:175], v[18:19], v[64:65], v[174:175] op_sel:[0,0,0] op_sel_hi:[1,0,1]
    v_exp_f32 v84, v84
    v_exp_f32 v85, v85
    v_pk_fma_f32 v[248:249], v[12:13], v[66:67], v[248:249] op_sel:[0,0,0] op_sel_hi:[1,0,1]
    v_exp_f32 v86, v86
    v_exp_f32 v87, v87
    v_pk_fma_f32 v[250:251], v[14:15], v[66:67], v[250:251] op_sel:[0,0,0] op_sel_hi:[1,0,1]
    v_exp_f32 v88, v88
    v_exp_f32 v89, v89
    v_pk_fma_f32 v[252:253], v[16:17], v[66:67], v[252:253] op_sel:[0,0,0] op_sel_hi:[1,0,1]
    v_exp_f32 v90, v90
    v_exp_f32 v91, v91
    v_pk_fma_f32 v[254:255], v[18:19], v[66:67], v[254:255] op_sel:[0,0,0] op_sel_hi:[1,0,1]
    v_pk_fma_f32 v[76:77], v[76:77], v[72:73], v[72:73] op_sel:[0,0,0] op_sel_hi:[1,0,0]
    v_pk_mul_f32 v[160:161], v[160:161], v[168:169] op_sel:[0,0] op_sel_hi:[1,1]
    v_pk_fma_f32 v[78:79], v[78:79], v[72:73], v[72:73] op_sel:[0,0,0] op_sel_hi:[1,0,0]
    v_pk_mul_f32 v[162:163], v[162:163], v[170:171] op_sel:[0,0] op_sel_hi:[1,1]
    v_pk_fma_f32 v[80:81], v[80:81], v[72:73], v[72:73] op_sel:[0,0,0] op_sel_hi:[1,0,0]
    v_pk_mul_f32 v[164:165], v[164:165], v[172:173] op_sel:[0,0] op_sel_hi:[1,1]
    v_pk_fma_f32 v[82:83], v[82:83], v[72:73], v[72:73] op_sel:[0,0,0] op_sel_hi:[1,0,0]
    v_pk_mul_f32 v[166:167], v[166:167], v[174:175] op_sel:[0,0] op_sel_hi:[1,1]
    v_pk_fma_f32 v[84:85], v[84:85], v[74:75], v[74:75] op_sel:[0,0,0] op_sel_hi:[1,0,0]
    v_pk_mul_f32 v[240:241], v[240:241], v[248:249] op_sel:[0,0] op_sel_hi:[1,1]
    v_pk_fma_f32 v[86:87], v[86:87], v[74:75], v[74:75] op_sel:[0,0,0] op_sel_hi:[1,0,0]
    v_pk_mul_f32 v[242:243], v[242:243], v[250:251] op_sel:[0,0] op_sel_hi:[1,1]
    v_pk_fma_f32 v[88:89], v[88:89], v[74:75], v[74:75] op_sel:[0,0,0] op_sel_hi:[1,0,0]
    v_pk_mul_f32 v[244:245], v[244:245], v[252:253] op_sel:[0,0] op_sel_hi:[1,1]
    v_pk_fma_f32 v[90:91], v[90:91], v[74:75], v[74:75] op_sel:[0,0,0] op_sel_hi:[1,0,0]
    v_pk_mul_f32 v[246:247], v[246:247], v[254:255] op_sel:[0,0] op_sel_hi:[1,1]
    v_rcp_f32 v76, v76
    v_rcp_f32 v77, v77
    v_rcp_f32 v78, v78
    v_rcp_f32 v79, v79
    v_rcp_f32 v80, v80
    v_rcp_f32 v81, v81
    v_rcp_f32 v82, v82
    v_rcp_f32 v83, v83
    v_rcp_f32 v84, v84
    v_rcp_f32 v85, v85
    v_rcp_f32 v86, v86
    v_rcp_f32 v87, v87
    v_rcp_f32 v88, v88
    v_rcp_f32 v89, v89
    v_rcp_f32 v90, v90
    v_rcp_f32 v91, v91
    v_pk_mul_f32 v[160:161], v[160:161], v[76:77] op_sel:[0,0] op_sel_hi:[1,1]
    v_pk_mul_f32 v[162:163], v[162:163], v[78:79] op_sel:[0,0] op_sel_hi:[1,1]
    v_pk_mul_f32 v[164:165], v[164:165], v[80:81] op_sel:[0,0] op_sel_hi:[1,1]
    v_pk_mul_f32 v[166:167], v[166:167], v[82:83] op_sel:[0,0] op_sel_hi:[1,1]
    v_pk_mul_f32 v[240:241], v[240:241], v[84:85] op_sel:[0,0] op_sel_hi:[1,1]
    v_pk_mul_f32 v[242:243], v[242:243], v[86:87] op_sel:[0,0] op_sel_hi:[1,1]
    v_pk_mul_f32 v[244:245], v[244:245], v[88:89] op_sel:[0,0] op_sel_hi:[1,1]
    v_pk_mul_f32 v[246:247], v[246:247], v[90:91] op_sel:[0,0] op_sel_hi:[1,1]
    s_mov_b32 s6, 6291456
    v_cvt_pk_bf16_f32 v168, v160, v161
    v_cvt_pk_bf16_f32 v169, v162, v163
    v_cvt_pk_bf16_f32 v170, v164, v165
    v_cvt_pk_bf16_f32 v171, v166, v167
    s_add_u32 s27, s30, 4096
    buffer_store_dwordx4 v[168:171], v71, s[4:7], s27 offen sc1
    v_cvt_pk_bf16_f32 v248, v240, v241
    v_cvt_pk_bf16_f32 v249, v242, v243
    v_cvt_pk_bf16_f32 v250, v244, v245
    v_cvt_pk_bf16_f32 v251, v246, v247
    s_add_u32 s27, s30, 102400
    buffer_store_dwordx4 v[248:251], v71, s[4:7], s27 offen sc1
K1_DONE:
    s_waitcnt vmcnt(0)
    s_endpgm
K1_LOADER:
    s_sub_u32 s19, s16, 4
    s_setprio 3
    v_lshrrev_b32 v58, 3, v0
    v_and_b32 v59, 7, v0
    v_lshrrev_b32 v60, 4, v0
    s_lshl_b32 s27, s17, 7
    s_lshl_b32 s29, s19, 5
    s_add_u32 s27, s27, s29
    v_xor_b32 v61, v60, v59
    v_lshlrev_b32 v61, 4, v61
    v_add_u32 v4, s27, v58
    v_mul_u32_u24 v4, 1280, v4
    v_xor_b32 v60, 64, v61
    v_add_u32 v5, v4, v60
    v_add_u32 v4, v4, v61
    v_add_u32 v5, 10240, v5
    v_add_u32 v6, 20480, v4
    v_add_u32 v7, 20480, v5
    s_waitcnt lgkmcnt(0)
    s_mov_b32 s8, s36
    s_mov_b32 s9, s37
    s_mov_b32 s10, 2621440
    s_mov_b32 s11, 0x00020000
    s_lshl_b32 s21, s19, 12
    s_mov_b32 s25, 0
    s_mov_b32 s26, s21
    s_add_u32 s30, s21, 49152
    s_add_u32 m0, s26, 0
    s_nop 0
    buffer_load_dwordx4 v4, s[8:11], s25 offen lds
    s_add_u32 m0, s26, 1024
    s_nop 0
    buffer_load_dwordx4 v5, s[8:11], s25 offen lds
    s_add_u32 m0, s26, 2048
    s_nop 0
    buffer_load_dwordx4 v6, s[8:11], s25 offen lds
    s_add_u32 m0, s26, 3072
    s_nop 0
    buffer_load_dwordx4 v7, s[8:11], s25 offen lds
    s_add_u32 s25, s25, 128
    s_add_u32 s26, s26, 16384
    s_cmp_eq_u32 s26, s30
    s_cselect_b32 s26, s21, s26
    s_cmp_ge_u32 s18, 6
    s_cbranch_scc1 K1_LD_FFN
    s_mul_i32 s27, s19, 320
    s_add_u32 s29, s27, 0
    v_add_u32 v58, s29, v0
    v_mul_u32_u24 v59, 1639, v58
    v_lshrrev_b32 v59, 16, v59
    v_mul_u32_u24 v60, 40, v59
    v_sub_u32 v58, v58, v60
    v_bfe_u32 v60, v59, 1, 1
    v_lshlrev_b32 v60, 2, v60
    v_xor_b32 v58, v58, v60
    v_lshlrev_b32 v58, 4, v58
    v_mul_u32_u24 v59, 3840, v59
    v_add_u32 v8, v58, v59
    s_add_u32 s29, s27, 64
    v_add_u32 v58, s29, v0
    v_mul_u32_u24 v59, 1639, v58
    v_lshrrev_b32 v59, 16, v59
    v_mul_u32_u24 v60, 40, v59
    v_sub_u32 v58, v58, v60
    v_bfe_u32 v60, v59, 1, 1
    v_lshlrev_b32 v60, 2, v60
    v_xor_b32 v58, v58, v60
    v_lshlrev_b32 v58, 4, v58
    v_mul_u32_u24 v59, 3840, v59
    v_add_u32 v9, v58, v59
    s_add_u32 s29, s27, 128
    v_add_u32 v58, s29, v0
    v_mul_u32_u24 v59, 1639, v58
    v_lshrrev_b32 v59, 16, v59
    v_mul_u32_u24 v60, 40, v59
    v_sub_u32 v58, v58, v60
    v_bfe_u32 v60, v59, 1, 1
    v_lshlrev_b32 v60, 2, v60
    v_xor_b32 v58, v58, v60
    v_lshlrev_b32 v58, 4, v58
    v_mul_u32_u24 v59, 3840, v59
    v_add_u32 v10, v58, v59
    s_add_u32 s29, s27, 192
    v_add_u32 v58, s29, v0
    v_mul_u32_u24 v59, 1639, v58
    v_lshrrev_b32 v59, 16, v59
    v_mul_u32_u24 v60, 40, v59
    v_sub_u32 v58, v58, v60
    v_bfe_u32 v60, v59, 1, 1
    v_lshlrev_b32 v60, 2, v60
    v_xor_b32 v58, v58, v60
    v_lshlrev_b32 v58, 4, v58
    v_mul_u32_u24 v59, 3840, v59
    v_add_u32 v11, v58, v59
    s_add_u32 s29, s27, 256
    v_add_u32 v58, s29, v0
    v_mul_u32_u24 v59, 1639, v58
    v_lshrrev_b32 v59, 16, v59
    v_mul_u32_u24 v60, 40, v59
    v_sub_u32 v58, v58, v60
    v_bfe_u32 v60, v59, 1, 1
    v_lshlrev_b32 v60, 2, v60
    v_xor_b32 v58, v58, v60
    v_lshlrev_b32 v58, 4, v58
    v_mul_u32_u24 v59, 3840, v59
    v_add_u32 v12, v58, v59
    s_mul_i32 s29, s18, 640
    v_add_u32 v8, s29, v8
    v_add_u32 v9, s29, v9
    v_add_u32 v10, s29, v10
    v_add_u32 v11, s29, v11
    v_add_u32 v12, s29, v12
    s_waitcnt lgkmcnt(0)
    s_mov_b32 s4, s38
    s_mov_b32 s5, s39
    s_mov_b32 s6, 2457600
    s_mov_b32 s22, 122880
    s_mul_i32 s20, s19, 5120
    s_branch K1_LD_GO
K1_LD_FFN:
    s_and_b32 s27, s19, 1
    s_lshl_b32 s27, s27, 4
    s_sub_u32 s29, s18, 6
    s_mul_i32 s29, s29, 320
    s_min_u32 s29, s29, 2752
    v_add_u32 v58, 0, v0
    v_mul_u32_u24 v59, 3277, v58
    v_lshrrev_b32 v59, 16, v59
    v_mul_u32_u24 v60, 20, v59
    v_sub_u32 v58, v58, v60
    v_lshlrev_b32 v58, 4, v58
    v_add_u32 v59, s27, v59
    v_mul_u32_u24 v59, 3072, v59
    v_add_u32 v8, v58, v59
    v_add_u32 v8, s29, v8
    v_add_u32 v58, 64, v0
    v_mul_u32_u24 v59, 3277, v58
    v_lshrrev_b32 v59, 16, v59
    v_mul_u32_u24 v60, 20, v59
    v_sub_u32 v58, v58, v60
    v_lshlrev_b32 v58, 4, v58
    v_add_u32 v59, s27, v59
    v_mul_u32_u24 v59, 3072, v59
    v_add_u32 v9, v58, v59
    v_add_u32 v9, s29, v9
    v_add_u32 v58, 128, v0
    v_mul_u32_u24 v59, 3277, v58
    v_lshrrev_b32 v59, 16, v59
    v_mul_u32_u24 v60, 20, v59
    v_sub_u32 v58, v58, v60
    v_lshlrev_b32 v58, 4, v58
    v_add_u32 v59, s27, v59
    v_mul_u32_u24 v59, 3072, v59
    v_add_u32 v10, v58, v59
    v_add_u32 v10, s29, v10
    v_add_u32 v58, 192, v0
    v_mul_u32_u24 v59, 3277, v58
    v_lshrrev_b32 v59, 16, v59
    v_mul_u32_u24 v60, 20, v59
    v_sub_u32 v58, v58, v60
    v_lshlrev_b32 v58, 4, v58
    v_add_u32 v59, s27, v59
    v_mul_u32_u24 v59, 3072, v59
    v_add_u32 v11, v58, v59
    v_add_u32 v11, s29, v11
    v_add_u32 v58, 256, v0
    v_mul_u32_u24 v59, 3277, v58
    v_lshrrev_b32 v59, 16, v59
    v_mul_u32_u24 v60, 20, v59
    v_sub_u32 v58, v58, v60
    v_lshlrev_b32 v58, 4, v58
    v_add_u32 v59, s27, v59
    v_mul_u32_u24 v59, 3072, v59
    v_add_u32 v12, v58, v59
    v_add_u32 v12, s29, v12
    s_waitcnt lgkmcnt(0)
    s_cmp_lt_u32 s19, 2
    s_cselect_b32 s4, s40, s42
    s_cselect_b32 s5, s41, s43
    s_mov_b32 s6, 1966080
    s_mov_b32 s22, 98304
    s_mul_i32 s20, s19, 5120
    s_lshr_b32 s27, s19, 1
    s_lshl_b32 s27, s27, 5
    s_add_u32 s20, s20, s27
K1_LD_GO:
    s_mov_b32 s7, 0x00020000
    s_add_u32 s20, s20, 49152
    s_mov_b32 s23, 0
    s_mov_b32 s24, s20
    s_add_u32 s29, s20, 102720
    s_add_u32 m0, s24, 0
    s_nop 0
    buffer_load_dwordx4 v8, s[4:7], s23 offen lds
    s_add_u32 m0, s24, 1024
    s_nop 0
    buffer_load_dwordx4 v9, s[4:7], s23 offen lds
    s_add_u32 m0, s24, 2048
    s_nop 0
    buffer_load_dwordx4 v10, s[4:7], s23 offen lds
    s_add_u32 m0, s24, 3072
    s_nop 0
    buffer_load_dwordx4 v11, s[4:7], s23 offen lds
    s_add_u32 m0, s24, 4096
    s_nop 0
    buffer_load_dwordx4 v12, s[4:7], s23 offen lds
    s_add_u32 s23, s23, s22
    s_add_u32 s24, s24, 20544
    s_cmp_eq_u32 s24, s29
    s_cselect_b32 s24, s20, s24
    s_add_u32 m0, s24, 0
    s_nop 0
    buffer_load_dwordx4 v8, s[4:7], s23 offen lds
    s_add_u32 m0, s24, 1024
    s_nop 0
    buffer_load_dwordx4 v9, s[4:7], s23 offen lds
    s_add_u32 m0, s24, 2048
    s_nop 0
    buffer_load_dwordx4 v10, s[4:7], s23 offen lds
    s_add_u32 m0, s24, 3072
    s_nop 0
    buffer_load_dwordx4 v11, s[4:7], s23 offen lds
    s_add_u32 m0, s24, 4096
    s_nop 0
    buffer_load_dwordx4 v12, s[4:7], s23 offen lds
    s_add_u32 s23, s23, s22
    s_add_u32 s24, s24, 20544
    s_cmp_eq_u32 s24, s29
    s_cselect_b32 s24, s20, s24
    s_add_u32 m0, s26, 0
    s_nop 0
    buffer_load_dwordx4 v4, s[8:11], s25 offen lds
    s_add_u32 m0, s26, 1024
    s_nop 0
    buffer_load_dwordx4 v5, s[8:11], s25 offen lds
    s_add_u32 m0, s26, 2048
    s_nop 0
    buffer_load_dwordx4 v6, s[8:11], s25 offen lds
    s_add_u32 m0, s26, 3072
    s_nop 0
    buffer_load_dwordx4 v7, s[8:11], s25 offen lds
    s_add_u32 s25, s25, 128
    s_add_u32 s26, s26, 16384
    s_cmp_eq_u32 s26, s30
    s_cselect_b32 s26, s21, s26
    s_setprio 0
    s_lshl_b32 s27, s2, 1
    s_add_u32 s27, s27, s19
    s_add_u32 s28, s2, 512
    s_cmp_eq_u32 s19, 2
    s_cselect_b32 s27, s28, s27
    s_cmp_lt_u32 s27, 544
    s_cselect_b32 s33, 1, 0
    s_cmp_eq_u32 s19, 3
    s_cselect_b32 s33, 0, s33
    s_and_b32 s32, s27, 7
    s_lshr_b32 s27, s27, 3
    s_mul_i32 s54, s32, 68
    s_add_u32 s54, s54, s27
    s_mul_i32 s54, s54, 5120
    s_mul_i32 s32, s32, 160
    s_lshl_b32 s28, s27, 5
    s_mov_b32 s55, 16
    s_mov_b32 s48, 8
    s_mov_b32 s49, 4
    s_mov_b32 s12, s52
    s_mov_b32 s13, s53
    s_mov_b32 s14, 1966080
    s_cmp_lt_u32 s27, 48
    s_cbranch_scc1 K1_WI_SET
    s_mov_b32 s12, s50
    s_mov_b32 s13, s51
    s_mov_b32 s14, 819200
    s_sub_u32 s27, s27, 48
    s_mul_i32 s28, s27, 40
    s_mov_b32 s55, 20
    s_cmp_lt_u32 s27, 16
    s_cbranch_scc1 K1_WI_SET
    s_sub_u32 s27, s27, 16
    s_mul_i32 s28, s27, 160
    s_add_u32 s28, s28, 16
    s_mov_b32 s55, 80
    s_mov_b32 s48, 20
    s_mov_b32 s49, 40
K1_WI_SET:
    s_mov_b32 s15, 0x00020000
    s_cmp_eq_u32 s33, 0
    s_cselect_b32 s14, 0, s14
    v_add_u32 v56, 0, v0
    v_mul_u32_u24 v57, 6554, v56
    v_lshrrev_b32 v57, 16, v57
    v_mul_u32_u24 v58, 10, v57
    v_sub_u32 v56, v56, v58
    v_lshlrev_b32 v56, 4, v56
    v_add_u32 v56, s32, v56
    v_lshrrev_b32 v58, 4, v57
    v_mul_u32_u24 v58, s55, v58
    v_bfe_u32 v59, v57, 3, 1
    v_mul_u32_u24 v59, s48, v59
    v_add_u32 v58, v58, v59
    v_bfe_u32 v59, v57, 2, 1
    v_mul_u32_u24 v59, s49, v59
    v_add_u32 v58, v58, v59
    v_and_b32 v59, 3, v57
    v_add_u32 v58, v58, v59
    v_add_u32 v58, s28, v58
    v_mul_u32_u24 v58, 1280, v58
    v_add_u32 v50, v56, v58
    v_add_u32 v56, 64, v0
    v_mul_u32_u24 v57, 6554, v56
    v_lshrrev_b32 v57, 16, v57
    v_mul_u32_u24 v58, 10, v57
    v_sub_u32 v56, v56, v58
    v_lshlrev_b32 v56, 4, v56
    v_add_u32 v56, s32, v56
    v_lshrrev_b32 v58, 4, v57
    v_mul_u32_u24 v58, s55, v58
    v_bfe_u32 v59, v57, 3, 1
    v_mul_u32_u24 v59, s48, v59
    v_add_u32 v58, v58, v59
    v_bfe_u32 v59, v57, 2, 1
    v_mul_u32_u24 v59, s49, v59
    v_add_u32 v58, v58, v59
    v_and_b32 v59, 3, v57
    v_add_u32 v58, v58, v59
    v_add_u32 v58, s28, v58
    v_mul_u32_u24 v58, 1280, v58
    v_add_u32 v51, v56, v58
    v_add_u32 v56, 128, v0
    v_mul_u32_u24 v57, 6554, v56
    v_lshrrev_b32 v57, 16, v57
    v_mul_u32_u24 v58, 10, v57
    v_sub_u32 v56, v56, v58
    v_lshlrev_b32 v56, 4, v56
    v_add_u32 v56, s32, v56
    v_lshrrev_b32 v58, 4, v57
    v_mul_u32_u24 v58, s55, v58
    v_bfe_u32 v59, v57, 3, 1
    v_mul_u32_u24 v59, s48, v59
    v_add_u32 v58, v58, v59
    v_bfe_u32 v59, v57, 2, 1
    v_mul_u32_u24 v59, s49, v59
    v_add_u32 v58, v58, v59
    v_and_b32 v59, 3, v57
    v_add_u32 v58, v58, v59
    v_add_u32 v58, s28, v58
    v_mul_u32_u24 v58, 1280, v58
    v_add_u32 v52, v56, v58
    v_add_u32 v56, 192, v0
    v_mul_u32_u24 v57, 6554, v56
    v_lshrrev_b32 v57, 16, v57
    v_mul_u32_u24 v58, 10, v57
    v_sub_u32 v56, v56, v58
    v_lshlrev_b32 v56, 4, v56
    v_add_u32 v56, s32, v56
    v_lshrrev_b32 v58, 4, v57
    v_mul_u32_u24 v58, s55, v58
    v_bfe_u32 v59, v57, 3, 1
    v_mul_u32_u24 v59, s48, v59
    v_add_u32 v58, v58, v59
    v_bfe_u32 v59, v57, 2, 1
    v_mul_u32_u24 v59, s49, v59
    v_add_u32 v58, v58, v59
    v_and_b32 v59, 3, v57
    v_add_u32 v58, v58, v59
    v_add_u32 v58, s28, v58
    v_mul_u32_u24 v58, 1280, v58
    v_add_u32 v53, v56, v58
    v_add_u32 v56, 256, v0
    v_mul_u32_u24 v57, 6554, v56
    v_lshrrev_b32 v57, 16, v57
    v_mul_u32_u24 v58, 10, v57
    v_sub_u32 v56, v56, v58
    v_lshlrev_b32 v56, 4, v56
    v_add_u32 v56, s32, v56
    v_lshrrev_b32 v58, 4, v57
    v_mul_u32_u24 v58, s55, v58
    v_bfe_u32 v59, v57, 3, 1
    v_mul_u32_u24 v59, s48, v59
    v_add_u32 v58, v58, v59
    v_bfe_u32 v59, v57, 2, 1
    v_mul_u32_u24 v59, s49, v59
    v_add_u32 v58, v58, v59
    v_and_b32 v59, 3, v57
    v_add_u32 v58, v58, v59
    v_add_u32 v58, s28, v58
    v_mul_u32_u24 v58, 1280, v58
    v_add_u32 v54, v56, v58
    v_and_b32 v58, 31, v0
    v_lshrrev_b32 v59, 5, v0
    v_lshlrev_b32 v59, 2, v59
    v_bfe_u32 v60, v0, 1, 3
    v_xor_b32 v59, v59, v60
    v_lshlrev_b32 v59, 4, v59
    v_lshlrev_b32 v60, 7, v58
    v_add_u32 v59, v59, v60
    v_add_u32 v16, s21, v59
    v_xor_b32 v17, 16, v16
    v_xor_b32 v18, 32, v16
    v_xor_b32 v19, 48, v16
    v_mov_b32 v40, 0
    v_mov_b32 v41, 0
    v_mov_b32 v42, 0
    v_mov_b32 v43, 0
    s_mov_b32 s27, 0
    s_mov_b32 s46, 16384
    s_mov_b32 s47, 4294934528
    s_waitcnt vmcnt(9)
    s_barrier
    s_add_u32 m0, s24, 0
    s_nop 0
    buffer_load_dwordx4 v8, s[4:7], s23 offen lds
    s_add_u32 m0, s24, 1024
    s_nop 0
    buffer_load_dwordx4 v9, s[4:7], s23 offen lds
    s_add_u32 m0, s24, 2048
    s_nop 0
    buffer_load_dwordx4 v10, s[4:7], s23 offen lds
    s_add_u32 m0, s24, 3072
    s_nop 0
    buffer_load_dwordx4 v11, s[4:7], s23 offen lds
    s_add_u32 m0, s24, 4096
    s_nop 0
    buffer_load_dwordx4 v12, s[4:7], s23 offen lds
    s_add_u32 s23, s23, s22
    s_add_u32 s24, s24, 20544
    s_cmp_eq_u32 s24, s29
    s_cselect_b32 s24, s20, s24
    ds_read_b128 v[20:23], v16
    ds_read_b128 v[24:27], v17
    ds_read_b128 v[28:31], v18
    ds_read_b128 v[32:35], v19
    s_add_u32 s27, s27, 1
    s_cmp_eq_u32 s27, 3
    s_cselect_b32 s28, s47, s46
    s_cselect_b32 s27, 0, s27
    v_add_u32 v16, s28, v16
    v_add_u32 v17, s28, v17
    v_add_u32 v18, s28, v18
    v_add_u32 v19, s28, v19
    s_waitcnt lgkmcnt(2)
    v_lshlrev_b32 v36, 16, v20
    v_and_b32 v37, 0xffff0000, v20
    v_lshlrev_b32 v38, 16, v21
    v_and_b32 v39, 0xffff0000, v21
    v_add_f32 v40, v40, v36
    v_add_f32 v41, v41, v37
    v_fma_f32 v42, v36, v36, v42
    v_fma_f32 v43, v37, v37, v43
    v_add_f32 v40, v40, v38
    v_add_f32 v41, v41, v39
    v_fma_f32 v42, v38, v38, v42
    v_fma_f32 v43, v39, v39, v43
    v_lshlrev_b32 v36, 16, v22
    v_and_b32 v37, 0xffff0000, v22
    v_lshlrev_b32 v38, 16, v23
    v_and_b32 v39, 0xffff0000, v23
    v_add_f32 v40, v40, v36
    v_add_f32 v41, v41, v37
    v_fma_f32 v42, v36, v36, v42
    v_fma_f32 v43, v37, v37, v43
    v_add_f32 v40, v40, v38
    v_add_f32 v41, v41, v39
    v_fma_f32 v42, v38, v38, v42
    v_fma_f32 v43, v39, v39, v43
    v_lshlrev_b32 v36, 16, v24
    v_and_b32 v37, 0xffff0000, v24
    v_lshlrev_b32 v38, 16, v25
    v_and_b32 v39, 0xffff0000, v25
    v_add_f32 v40, v40, v36
    v_add_f32 v41, v41, v37
    v_fma_f32 v42, v36, v36, v42
    v_fma_f32 v43, v37, v37, v43
    v_add_f32 v40, v40, v38
    v_add_f32 v41, v41, v39
    v_fma_f32 v42, v38, v38, v42
    v_fma_f32 v43, v39, v39, v43
    v_lshlrev_b32 v36, 16, v26
    v_and_b32 v37, 0xffff0000, v26
    v_lshlrev_b32 v38, 16, v27
    v_and_b32 v39, 0xffff0000, v27
    v_add_f32 v40, v40, v36
    v_add_f32 v41, v41, v37
    v_fma_f32 v42, v36, v36, v42
    v_fma_f32 v43, v37, v37, v43
    v_add_f32 v40, v40, v38
    v_add_f32 v41, v41, v39
    v_fma_f32 v42, v38, v38, v42
    v_fma_f32 v43, v39, v39, v43
    s_waitcnt vmcnt(9)
    s_barrier
    s_add_u32 m0, s24, 0
    s_nop 0
    buffer_load_dwordx4 v8, s[4:7], s23 offen lds
    s_add_u32 m0, s24, 1024
    s_nop 0
    buffer_load_dwordx4 v9, s[4:7], s23 offen lds
    s_add_u32 m0, s24, 2048
    s_nop 0
    buffer_load_dwordx4 v10, s[4:7], s23 offen lds
    s_add_u32 m0, s24, 3072
    s_nop 0
    buffer_load_dwordx4 v11, s[4:7], s23 offen lds
    s_add_u32 m0, s24, 4096
    s_nop 0
    buffer_load_dwordx4 v12, s[4:7], s23 offen lds
    s_add_u32 s23, s23, s22
    s_add_u32 s24, s24, 20544
    s_cmp_eq_u32 s24, s29
    s_cselect_b32 s24, s20, s24
    s_add_u32 m0, s26, 0
    s_nop 0
    buffer_load_dwordx4 v4, s[8:11], s25 offen lds
    s_add_u32 m0, s26, 1024
    s_nop 0
    buffer_load_dwordx4 v5, s[8:11], s25 offen lds
    s_add_u32 m0, s26, 2048
    s_nop 0
    buffer_load_dwordx4 v6, s[8:11], s25 offen lds
    s_add_u32 m0, s26, 3072
    s_nop 0
    buffer_load_dwordx4 v7, s[8:11], s25 offen lds
    s_add_u32 s25, s25, 128
    s_add_u32 s26, s26, 16384
    s_cmp_eq_u32 s26, s30
    s_cselect_b32 s26, s21, s26
    s_waitcnt lgkmcnt(0)
    v_lshlrev_b32 v36, 16, v28
    v_and_b32 v37, 0xffff0000, v28
    v_lshlrev_b32 v38, 16, v29
    v_and_b32 v39, 0xffff0000, v29
    v_add_f32 v40, v40, v36
    v_add_f32 v41, v41, v37
    v_fma_f32 v42, v36, v36, v42
    v_fma_f32 v43, v37, v37, v43
    v_add_f32 v40, v40, v38
    v_add_f32 v41, v41, v39
    v_fma_f32 v42, v38, v38, v42
    v_fma_f32 v43, v39, v39, v43
    v_lshlrev_b32 v36, 16, v30
    v_and_b32 v37, 0xffff0000, v30
    v_lshlrev_b32 v38, 16, v31
    v_and_b32 v39, 0xffff0000, v31
    v_add_f32 v40, v40, v36
    v_add_f32 v41, v41, v37
    v_fma_f32 v42, v36, v36, v42
    v_fma_f32 v43, v37, v37, v43
    v_add_f32 v40, v40, v38
    v_add_f32 v41, v41, v39
    v_fma_f32 v42, v38, v38, v42
    v_fma_f32 v43, v39, v39, v43
    v_lshlrev_b32 v36, 16, v32
    v_and_b32 v37, 0xffff0000, v32
    v_lshlrev_b32 v38, 16, v33
    v_and_b32 v39, 0xffff0000, v33
    v_add_f32 v40, v40, v36
    v_add_f32 v41, v41, v37
    v_fma_f32 v42, v36, v36, v42
    v_fma_f32 v43, v37, v37, v43
    v_add_f32 v40, v40, v38
    v_add_f32 v41, v41, v39
    v_fma_f32 v42, v38, v38, v42
    v_fma_f32 v43, v39, v39, v43
    v_lshlrev_b32 v36, 16, v34
    v_and_b32 v37, 0xffff0000, v34
    v_lshlrev_b32 v38, 16, v35
    v_and_b32 v39, 0xffff0000, v35
    v_add_f32 v40, v40, v36
    v_add_f32 v41, v41, v37
    v_fma_f32 v42, v36, v36, v42
    v_fma_f32 v43, v37, v37, v43
    v_add_f32 v40, v40, v38
    v_add_f32 v41, v41, v39
    v_fma_f32 v42, v38, v38, v42
    v_fma_f32 v43, v39, v39, v43
    s_waitcnt vmcnt(9)
    s_barrier
    s_add_u32 m0, s24, 0
    s_nop 0
    buffer_load_dwordx4 v8, s[4:7], s23 offen lds
    s_add_u32 m0, s24, 1024
    s_nop 0
    buffer_load_dwordx4 v9, s[4:7], s23 offen lds
    s_add_u32 m0, s24, 2048
    s_nop 0
    buffer_load_dwordx4 v10, s[4:7], s23 offen lds
    s_add_u32 m0, s24, 3072
    s_nop 0
    buffer_load_dwordx4 v11, s[4:7], s23 offen lds
    s_add_u32 m0, s24, 4096
    s_nop 0
    buffer_load_dwordx4 v12, s[4:7], s23 offen lds
    s_add_u32 s23, s23, s22
    s_add_u32 s24, s24, 20544
    s_cmp_eq_u32 s24, s29
    s_cselect_b32 s24, s20, s24
    s_add_u32 m0, s24, 0
    s_nop 0
    buffer_load_dwordx4 v8, s[4:7], s23 offen lds
    s_add_u32 m0, s24, 1024
    s_nop 0
    buffer_load_dwordx4 v9, s[4:7], s23 offen lds
    s_add_u32 m0, s24, 2048
    s_nop 0
    buffer_load_dwordx4 v10, s[4:7], s23 offen lds
    s_add_u32 m0, s24, 3072
    s_nop 0
    buffer_load_dwordx4 v11, s[4:7], s23 offen lds
    s_add_u32 m0, s24, 4096
    s_nop 0
    buffer_load_dwordx4 v12, s[4:7], s23 offen lds
    s_add_u32 s23, s23, s22
    s_add_u32 s24, s24, 20544
    s_cmp_eq_u32 s24, s29
    s_cselect_b32 s24, s20, s24
    ds_read_b128 v[20:23], v16
    ds_read_b128 v[24:27], v17
    ds_read_b128 v[28:31], v18
    ds_read_b128 v[32:35], v19
    s_add_u32 s27, s27, 1
    s_cmp_eq_u32 s27, 3
    s_cselect_b32 s28, s47, s46
    s_cselect_b32 s27, 0, s27
    v_add_u32 v16, s28, v16
    v_add_u32 v17, s28, v17
    v_add_u32 v18, s28, v18
    v_add_u32 v19, s28, v19
    s_waitcnt lgkmcnt(2)
    v_lshlrev_b32 v36, 16, v20
    v_and_b32 v37, 0xffff0000, v20
    v_lshlrev_b32 v38, 16, v21
    v_and_b32 v39, 0xffff0000, v21
    v_add_f32 v40, v40, v36
    v_add_f32 v41, v41, v37
    v_fma_f32 v42, v36, v36, v42
    v_fma_f32 v43, v37, v37, v43
    v_add_f32 v40, v40, v38
    v_add_f32 v41, v41, v39
    v_fma_f32 v42, v38, v38, v42
    v_fma_f32 v43, v39, v39, v43
    v_lshlrev_b32 v36, 16, v22
    v_and_b32 v37, 0xffff0000, v22
    v_lshlrev_b32 v38, 16, v23
    v_and_b32 v39, 0xffff0000, v23
    v_add_f32 v40, v40, v36
    v_add_f32 v41, v41, v37
    v_fma_f32 v42, v36, v36, v42
    v_fma_f32 v43, v37, v37, v43
    v_add_f32 v40, v40, v38
    v_add_f32 v41, v41, v39
    v_fma_f32 v42, v38, v38, v42
    v_fma_f32 v43, v39, v39, v43
    v_lshlrev_b32 v36, 16, v24
    v_and_b32 v37, 0xffff0000, v24
    v_lshlrev_b32 v38, 16, v25
    v_and_b32 v39, 0xffff0000, v25
    v_add_f32 v40, v40, v36
    v_add_f32 v41, v41, v37
    v_fma_f32 v42, v36, v36, v42
    v_fma_f32 v43, v37, v37, v43
    v_add_f32 v40, v40, v38
    v_add_f32 v41, v41, v39
    v_fma_f32 v42, v38, v38, v42
    v_fma_f32 v43, v39, v39, v43
    v_lshlrev_b32 v36, 16, v26
    v_and_b32 v37, 0xffff0000, v26
    v_lshlrev_b32 v38, 16, v27
    v_and_b32 v39, 0xffff0000, v27
    v_add_f32 v40, v40, v36
    v_add_f32 v41, v41, v37
    v_fma_f32 v42, v36, v36, v42
    v_fma_f32 v43, v37, v37, v43
    v_add_f32 v40, v40, v38
    v_add_f32 v41, v41, v39
    v_fma_f32 v42, v38, v38, v42
    v_fma_f32 v43, v39, v39, v43
    s_waitcnt vmcnt(14)
    s_barrier
    s_add_u32 m0, s24, 0
    s_nop 0
    buffer_load_dwordx4 v8, s[4:7], s23 offen lds
    s_add_u32 m0, s24, 1024
    s_nop 0
    buffer_load_dwordx4 v9, s[4:7], s23 offen lds
    s_add_u32 m0, s24, 2048
    s_nop 0
    buffer_load_dwordx4 v10, s[4:7], s23 offen lds
    s_add_u32 m0, s24, 3072
    s_nop 0
    buffer_load_dwordx4 v11, s[4:7], s23 offen lds
    s_add_u32 m0, s24, 4096
    s_nop 0
    buffer_load_dwordx4 v12, s[4:7], s23 offen lds
    s_add_u32 s23, s23, s22
    s_add_u32 s24, s24, 20544
    s_cmp_eq_u32 s24, s29
    s_cselect_b32 s24, s20, s24
    s_add_u32 m0, s26, 0
    s_nop 0
    buffer_load_dwordx4 v4, s[8:11], s25 offen lds
    s_add_u32 m0, s26, 1024
    s_nop 0
    buffer_load_dwordx4 v5, s[8:11], s25 offen lds
    s_add_u32 m0, s26, 2048
    s_nop 0
    buffer_load_dwordx4 v6, s[8:11], s25 offen lds
    s_add_u32 m0, s26, 3072
    s_nop 0
    buffer_load_dwordx4 v7, s[8:11], s25 offen lds
    s_add_u32 s25, s25, 128
    s_add_u32 s26, s26, 16384
    s_cmp_eq_u32 s26, s30
    s_cselect_b32 s26, s21, s26
    s_waitcnt lgkmcnt(0)
    v_lshlrev_b32 v36, 16, v28
    v_and_b32 v37, 0xffff0000, v28
    v_lshlrev_b32 v38, 16, v29
    v_and_b32 v39, 0xffff0000, v29
    v_add_f32 v40, v40, v36
    v_add_f32 v41, v41, v37
    v_fma_f32 v42, v36, v36, v42
    v_fma_f32 v43, v37, v37, v43
    v_add_f32 v40, v40, v38
    v_add_f32 v41, v41, v39
    v_fma_f32 v42, v38, v38, v42
    v_fma_f32 v43, v39, v39, v43
    v_lshlrev_b32 v36, 16, v30
    v_and_b32 v37, 0xffff0000, v30
    v_lshlrev_b32 v38, 16, v31
    v_and_b32 v39, 0xffff0000, v31
    v_add_f32 v40, v40, v36
    v_add_f32 v41, v41, v37
    v_fma_f32 v42, v36, v36, v42
    v_fma_f32 v43, v37, v37, v43
    v_add_f32 v40, v40, v38
    v_add_f32 v41, v41, v39
    v_fma_f32 v42, v38, v38, v42
    v_fma_f32 v43, v39, v39, v43
    v_lshlrev_b32 v36, 16, v32
    v_and_b32 v37, 0xffff0000, v32
    v_lshlrev_b32 v38, 16, v33
    v_and_b32 v39, 0xffff0000, v33
    v_add_f32 v40, v40, v36
    v_add_f32 v41, v41, v37
    v_fma_f32 v42, v36, v36, v42
    v_fma_f32 v43, v37, v37, v43
    v_add_f32 v40, v40, v38
    v_add_f32 v41, v41, v39
    v_fma_f32 v42, v38, v38, v42
    v_fma_f32 v43, v39, v39, v43
    v_lshlrev_b32 v36, 16, v34
    v_and_b32 v37, 0xffff0000, v34
    v_lshlrev_b32 v38, 16, v35
    v_and_b32 v39, 0xffff0000, v35
    v_add_f32 v40, v40, v36
    v_add_f32 v41, v41, v37
    v_fma_f32 v42, v36, v36, v42
    v_fma_f32 v43, v37, v37, v43
    v_add_f32 v40, v40, v38
    v_add_f32 v41, v41, v39
    v_fma_f32 v42, v38, v38, v42
    v_fma_f32 v43, v39, v39, v43
    s_mov_b32 s31, 2
K1_LD_LOOP:
    s_waitcnt vmcnt(14)
    s_barrier
    s_add_u32 m0, s24, 0
    s_nop 0
    buffer_load_dwordx4 v8, s[4:7], s23 offen lds
    s_add_u32 m0, s24, 1024
    s_nop 0
    buffer_load_dwordx4 v9, s[4:7], s23 offen lds
    s_add_u32 m0, s24, 2048
    s_nop 0
    buffer_load_dwordx4 v10, s[4:7], s23 offen lds
    s_add_u32 m0, s24, 3072
    s_nop 0
    buffer_load_dwordx4 v11, s[4:7], s23 offen lds
    s_add_u32 m0, s24, 4096
    s_nop 0
    buffer_load_dwordx4 v12, s[4:7], s23 offen lds
    s_add_u32 s23, s23, s22
    s_add_u32 s24, s24, 20544
    s_cmp_eq_u32 s24, s29
    s_cselect_b32 s24, s20, s24
    ds_read_b128 v[20:23], v16
    ds_read_b128 v[24:27], v17
    ds_read_b128 v[28:31], v18
    ds_read_b128 v[32:35], v19
    s_add_u32 s27, s27, 1
    s_cmp_eq_u32 s27, 3
    s_cselect_b32 s28, s47, s46
    s_cselect_b32 s27, 0, s27
    v_add_u32 v16, s28, v16
    v_add_u32 v17, s28, v17
    v_add_u32 v18, s28, v18
    v_add_u32 v19, s28, v19
    s_waitcnt lgkmcnt(2)
    v_lshlrev_b32 v36, 16, v20
    v_and_b32 v37, 0xffff0000, v20
    v_lshlrev_b32 v38, 16, v21
    v_and_b32 v39, 0xffff0000, v21
    v_add_f32 v40, v40, v36
    v_add_f32 v41, v41, v37
    v_fma_f32 v42, v36, v36, v42
    v_fma_f32 v43, v37, v37, v43
    v_add_f32 v40, v40, v38
    v_add_f32 v41, v41, v39
    v_fma_f32 v42, v38, v38, v42
    v_fma_f32 v43, v39, v39, v43
    v_lshlrev_b32 v36, 16, v22
    v_and_b32 v37, 0xffff0000, v22
    v_lshlrev_b32 v38, 16, v23
    v_and_b32 v39, 0xffff0000, v23
    v_add_f32 v40, v40, v36
    v_add_f32 v41, v41, v37
    v_fma_f32 v42, v36, v36, v42
    v_fma_f32 v43, v37, v37, v43
    v_add_f32 v40, v40, v38
    v_add_f32 v41, v41, v39
    v_fma_f32 v42, v38, v38, v42
    v_fma_f32 v43, v39, v39, v43
    v_lshlrev_b32 v36, 16, v24
    v_and_b32 v37, 0xffff0000, v24
    v_lshlrev_b32 v38, 16, v25
    v_and_b32 v39, 0xffff0000, v25
    v_add_f32 v40, v40, v36
    v_add_f32 v41, v41, v37
    v_fma_f32 v42, v36, v36, v42
    v_fma_f32 v43, v37, v37, v43
    v_add_f32 v40, v40, v38
    v_add_f32 v41, v41, v39
    v_fma_f32 v42, v38, v38, v42
    v_fma_f32 v43, v39, v39, v43
    v_lshlrev_b32 v36, 16, v26
    v_and_b32 v37, 0xffff0000, v26
    v_lshlrev_b32 v38, 16, v27
    v_and_b32 v39, 0xffff0000, v27
    v_add_f32 v40, v40, v36
    v_add_f32 v41, v41, v37
    v_fma_f32 v42, v36, v36, v42
    v_fma_f32 v43, v37, v37, v43
    v_add_f32 v40, v40, v38
    v_add_f32 v41, v41, v39
    v_fma_f32 v42, v38, v38, v42
    v_fma_f32 v43, v39, v39, v43
    s_waitcnt vmcnt(14)
    s_barrier
    s_add_u32 m0, s24, 0
    s_nop 0
    buffer_load_dwordx4 v8, s[4:7], s23 offen lds
    s_add_u32 m0, s24, 1024
    s_nop 0
    buffer_load_dwordx4 v9, s[4:7], s23 offen lds
    s_add_u32 m0, s24, 2048
    s_nop 0
    buffer_load_dwordx4 v10, s[4:7], s23 offen lds
    s_add_u32 m0, s24, 3072
    s_nop 0
    buffer_load_dwordx4 v11, s[4:7], s23 offen lds
    s_add_u32 m0, s24, 4096
    s_nop 0
    buffer_load_dwordx4 v12, s[4:7], s23 offen lds
    s_add_u32 s23, s23, s22
    s_add_u32 s24, s24, 20544
    s_cmp_eq_u32 s24, s29
    s_cselect_b32 s24, s20, s24
    s_add_u32 m0, s26, 0
    s_nop 0
    buffer_load_dwordx4 v4, s[8:11], s25 offen lds
    s_add_u32 m0, s26, 1024
    s_nop 0
    buffer_load_dwordx4 v5, s[8:11], s25 offen lds
    s_add_u32 m0, s26, 2048
    s_nop 0
    buffer_load_dwordx4 v6, s[8:11], s25 offen lds
    s_add_u32 m0, s26, 3072
    s_nop 0
    buffer_load_dwordx4 v7, s[8:11], s25 offen lds
    s_add_u32 s25, s25, 128
    s_add_u32 s26, s26, 16384
    s_cmp_eq_u32 s26, s30
    s_cselect_b32 s26, s21, s26
    s_waitcnt lgkmcnt(0)
    v_lshlrev_b32 v36, 16, v28
    v_and_b32 v37, 0xffff0000, v28
    v_lshlrev_b32 v38, 16, v29
    v_and_b32 v39, 0xffff0000, v29
    v_add_f32 v40, v40, v36
    v_add_f32 v41, v41, v37
    v_fma_f32 v42, v36, v36, v42
    v_fma_f32 v43, v37, v37, v43
    v_add_f32 v40, v40, v38
    v_add_f32 v41, v41, v39
    v_fma_f32 v42, v38, v38, v42
    v_fma_f32 v43, v39, v39, v43
    v_lshlrev_b32 v36, 16, v30
    v_and_b32 v37, 0xffff0000, v30
    v_lshlrev_b32 v38, 16, v31
    v_and_b32 v39, 0xffff0000, v31
    v_add_f32 v40, v40, v36
    v_add_f32 v41, v41, v37
    v_fma_f32 v42, v36, v36, v42
    v_fma_f32 v43, v37, v37, v43
    v_add_f32 v40, v40, v38
    v_add_f32 v41, v41, v39
    v_fma_f32 v42, v38, v38, v42
    v_fma_f32 v43, v39, v39, v43
    v_lshlrev_b32 v36, 16, v32
    v_and_b32 v37, 0xffff0000, v32
    v_lshlrev_b32 v38, 16, v33
    v_and_b32 v39, 0xffff0000, v33
    v_add_f32 v40, v40, v36
    v_add_f32 v41, v41, v37
    v_fma_f32 v42, v36, v36, v42
    v_fma_f32 v43, v37, v37, v43
    v_add_f32 v40, v40, v38
    v_add_f32 v41, v41, v39
    v_fma_f32 v42, v38, v38, v42
    v_fma_f32 v43, v39, v39, v43
    v_lshlrev_b32 v36, 16, v34
    v_and_b32 v37, 0xffff0000, v34
    v_lshlrev_b32 v38, 16, v35
    v_and_b32 v39, 0xffff0000, v35
    v_add_f32 v40, v40, v36
    v_add_f32 v41, v41, v37
    v_fma_f32 v42, v36, v36, v42
    v_fma_f32 v43, v37, v37, v43
    v_add_f32 v40, v40, v38
    v_add_f32 v41, v41, v39
    v_fma_f32 v42, v38, v38, v42
    v_fma_f32 v43, v39, v39, v43
    s_add_u32 s31, s31, 1
    s_cmp_lt_u32 s31, 8
    s_cbranch_scc1 K1_LD_LOOP
    s_waitcnt vmcnt(14)
    s_barrier
    s_add_u32 m0, s24, 0
    s_nop 0
    buffer_load_dwordx4 v8, s[4:7], s23 offen lds
    s_add_u32 m0, s24, 1024
    s_nop 0
    buffer_load_dwordx4 v9, s[4:7], s23 offen lds
    s_add_u32 m0, s24, 2048
    s_nop 0
    buffer_load_dwordx4 v10, s[4:7], s23 offen lds
    s_add_u32 m0, s24, 3072
    s_nop 0
    buffer_load_dwordx4 v11, s[4:7], s23 offen lds
    s_add_u32 m0, s24, 4096
    s_nop 0
    buffer_load_dwordx4 v12, s[4:7], s23 offen lds
    s_add_u32 s23, s23, s22
    s_add_u32 s24, s24, 20544
    s_cmp_eq_u32 s24, s29
    s_cselect_b32 s24, s20, s24
    ds_read_b128 v[20:23], v16
    ds_read_b128 v[24:27], v17
    ds_read_b128 v[28:31], v18
    ds_read_b128 v[32:35], v19
    s_add_u32 s27, s27, 1
    s_cmp_eq_u32 s27, 3
    s_cselect_b32 s28, s47, s46
    s_cselect_b32 s27, 0, s27
    v_add_u32 v16, s28, v16
    v_add_u32 v17, s28, v17
    v_add_u32 v18, s28, v18
    v_add_u32 v19, s28, v19
    s_waitcnt lgkmcnt(2)
    v_lshlrev_b32 v36, 16, v20
    v_and_b32 v37, 0xffff0000, v20
    v_lshlrev_b32 v38, 16, v21
    v_and_b32 v39, 0xffff0000, v21
    v_add_f32 v40, v40, v36
    v_add_f32 v41, v41, v37
    v_fma_f32 v42, v36, v36, v42
    v_fma_f32 v43, v37, v37, v43
    v_add_f32 v40, v40, v38
    v_add_f32 v41, v41, v39
    v_fma_f32 v42, v38, v38, v42
    v_fma_f32 v43, v39, v39, v43
    v_lshlrev_b32 v36, 16, v22
    v_and_b32 v37, 0xffff0000, v22
    v_lshlrev_b32 v38, 16, v23
    v_and_b32 v39, 0xffff0000, v23
    v_add_f32 v40, v40, v36
    v_add_f32 v41, v41, v37
    v_fma_f32 v42, v36, v36, v42
    v_fma_f32 v43, v37, v37, v43
    v_add_f32 v40, v40, v38
    v_add_f32 v41, v41, v39
    v_fma_f32 v42, v38, v38, v42
    v_fma_f32 v43, v39, v39, v43
    v_lshlrev_b32 v36, 16, v24
    v_and_b32 v37, 0xffff0000, v24
    v_lshlrev_b32 v38, 16, v25
    v_and_b32 v39, 0xffff0000, v25
    v_add_f32 v40, v40, v36
    v_add_f32 v41, v41, v37
    v_fma_f32 v42, v36, v36, v42
    v_fma_f32 v43, v37, v37, v43
    v_add_f32 v40, v40, v38
    v_add_f32 v41, v41, v39
    v_fma_f32 v42, v38, v38, v42
    v_fma_f32 v43, v39, v39, v43
    v_lshlrev_b32 v36, 16, v26
    v_and_b32 v37, 0xffff0000, v26
    v_lshlrev_b32 v38, 16, v27
    v_and_b32 v39, 0xffff0000, v27
    v_add_f32 v40, v40, v36
    v_add_f32 v41, v41, v37
    v_fma_f32 v42, v36, v36, v42
    v_fma_f32 v43, v37, v37, v43
    v_add_f32 v40, v40, v38
    v_add_f32 v41, v41, v39
    v_fma_f32 v42, v38, v38, v42
    v_fma_f32 v43, v39, v39, v43
    s_waitcnt vmcnt(14)
    s_barrier
    s_add_u32 m0, s20, 0
    s_nop 0
    buffer_load_dwordx4 v50, s[12:15], 0 offen lds
    s_add_u32 m0, s20, 1024
    s_nop 0
    buffer_load_dwordx4 v51, s[12:15], 0 offen lds
    s_add_u32 m0, s20, 2048
    s_nop 0
    buffer_load_dwordx4 v52, s[12:15], 0 offen lds
    s_add_u32 m0, s20, 3072
    s_nop 0
    buffer_load_dwordx4 v53, s[12:15], 0 offen lds
    s_add_u32 m0, s20, 4096
    s_nop 0
    buffer_load_dwordx4 v54, s[12:15], 0 offen lds
    s_waitcnt lgkmcnt(0)
    v_lshlrev_b32 v36, 16, v28
    v_and_b32 v37, 0xffff0000, v28
    v_lshlrev_b32 v38, 16, v29
    v_and_b32 v39, 0xffff0000, v29
    v_add_f32 v40, v40, v36
    v_add_f32 v41, v41, v37
    v_fma_f32 v42, v36, v36, v42
    v_fma_f32 v43, v37, v37, v43
    v_add_f32 v40, v40, v38
    v_add_f32 v41, v41, v39
    v_fma_f32 v42, v38, v38, v42
    v_fma_f32 v43, v39, v39, v43
    v_lshlrev_b32 v36, 16, v30
    v_and_b32 v37, 0xffff0000, v30
    v_lshlrev_b32 v38, 16, v31
    v_and_b32 v39, 0xffff0000, v31
    v_add_f32 v40, v40, v36
    v_add_f32 v41, v41, v37
    v_fma_f32 v42, v36, v36, v42
    v_fma_f32 v43, v37, v37, v43
    v_add_f32 v40, v40, v38
    v_add_f32 v41, v41, v39
    v_fma_f32 v42, v38, v38, v42
    v_fma_f32 v43, v39, v39, v43
    v_lshlrev_b32 v36, 16, v32
    v_and_b32 v37, 0xffff0000, v32
    v_lshlrev_b32 v38, 16, v33
    v_and_b32 v39, 0xffff0000, v33
    v_add_f32 v40, v40, v36
    v_add_f32 v41, v41, v37
    v_fma_f32 v42, v36, v36, v42
    v_fma_f32 v43, v37, v37, v43
    v_add_f32 v40, v40, v38
    v_add_f32 v41, v41, v39
    v_fma_f32 v42, v38, v38, v42
    v_fma_f32 v43, v39, v39, v43
    v_lshlrev_b32 v36, 16, v34
    v_and_b32 v37, 0xffff0000, v34
    v_lshlrev_b32 v38, 16, v35
    v_and_b32 v39, 0xffff0000, v35
    v_add_f32 v40, v40, v36
    v_add_f32 v41, v41, v37
    v_fma_f32 v42, v36, v36, v42
    v_fma_f32 v43, v37, v37, v43
    v_add_f32 v40, v40, v38
    v_add_f32 v41, v41, v39
    v_fma_f32 v42, v38, v38, v42
    v_fma_f32 v43, v39, v39, v43
    s_waitcnt vmcnt(10)
    s_barrier
    ds_read_b128 v[20:23], v16
    ds_read_b128 v[24:27], v17
    ds_read_b128 v[28:31], v18
    ds_read_b128 v[32:35], v19
    s_add_u32 s27, s27, 1
    s_cmp_eq_u32 s27, 3
    s_cselect_b32 s28, s47, s46
    s_cselect_b32 s27, 0, s27
    v_add_u32 v16, s28, v16
    v_add_u32 v17, s28, v17
    v_add_u32 v18, s28, v18
    v_add_u32 v19, s28, v19
    s_waitcnt lgkmcnt(2)
    v_lshlrev_b32 v36, 16, v20
    v_and_b32 v37, 0xffff0000, v20
    v_lshlrev_b32 v38, 16, v21
    v_and_b32 v39, 0xffff0000, v21
    v_add_f32 v40, v40, v36
    v_add_f32 v41, v41, v37
    v_fma_f32 v42, v36, v36, v42
    v_fma_f32 v43, v37, v37, v43
    v_add_f32 v40, v40, v38
    v_add_f32 v41, v41, v39
    v_fma_f32 v42, v38, v38, v42
    v_fma_f32 v43, v39, v39, v43
    v_lshlrev_b32 v36, 16, v22
    v_and_b32 v37, 0xffff0000, v22
    v_lshlrev_b32 v38, 16, v23
    v_and_b32 v39, 0xffff0000, v23
    v_add_f32 v40, v40, v36
    v_add_f32 v41, v41, v37
    v_fma_f32 v42, v36, v36, v42
    v_fma_f32 v43, v37, v37, v43
    v_add_f32 v40, v40, v38
    v_add_f32 v41, v41, v39
    v_fma_f32 v42, v38, v38, v42
    v_fma_f32 v43, v39, v39, v43
    v_lshlrev_b32 v36, 16, v24
    v_and_b32 v37, 0xffff0000, v24
    v_lshlrev_b32 v38, 16, v25
    v_and_b32 v39, 0xffff0000, v25
    v_add_f32 v40, v40, v36
    v_add_f32 v41, v41, v37
    v_fma_f32 v42, v36, v36, v42
    v_fma_f32 v43, v37, v37, v43
    v_add_f32 v40, v40, v38
    v_add_f32 v41, v41, v39
    v_fma_f32 v42, v38, v38, v42
    v_fma_f32 v43, v39, v39, v43
    v_lshlrev_b32 v36, 16, v26
    v_and_b32 v37, 0xffff0000, v26
    v_lshlrev_b32 v38, 16, v27
    v_and_b32 v39, 0xffff0000, v27
    v_add_f32 v40, v40, v36
    v_add_f32 v41, v41, v37
    v_fma_f32 v42, v36, v36, v42
    v_fma_f32 v43, v37, v37, v43
    v_add_f32 v40, v40, v38
    v_add_f32 v41, v41, v39
    v_fma_f32 v42, v38, v38, v42
    v_fma_f32 v43, v39, v39, v43
    s_waitcnt vmcnt(5)
    s_barrier
    s_waitcnt lgkmcnt(0)
    v_lshlrev_b32 v36, 16, v28
    v_and_b32 v37, 0xffff0000, v28
    v_lshlrev_b32 v38, 16, v29
    v_and_b32 v39, 0xffff0000, v29
    v_add_f32 v40, v40, v36
    v_add_f32 v41, v41, v37
    v_fma_f32 v42, v36, v36, v42
    v_fma_f32 v43, v37, v37, v43
    v_add_f32 v40, v40, v38
    v_add_f32 v41, v41, v39
    v_fma_f32 v42, v38, v38, v42
    v_fma_f32 v43, v39, v39, v43
    v_lshlrev_b32 v36, 16, v30
    v_and_b32 v37, 0xffff0000, v30
    v_lshlrev_b32 v38, 16, v31
    v_and_b32 v39, 0xffff0000, v31
    v_add_f32 v40, v40, v36
    v_add_f32 v41, v41, v37
    v_fma_f32 v42, v36, v36, v42
    v_fma_f32 v43, v37, v37, v43
    v_add_f32 v40, v40, v38
    v_add_f32 v41, v41, v39
    v_fma_f32 v42, v38, v38, v42
    v_fma_f32 v43, v39, v39, v43
    v_lshlrev_b32 v36, 16, v32
    v_and_b32 v37, 0xffff0000, v32
    v_lshlrev_b32 v38, 16, v33
    v_and_b32 v39, 0xffff0000, v33
    v_add_f32 v40, v40, v36
    v_add_f32 v41, v41, v37
    v_fma_f32 v42, v36, v36, v42
    v_fma_f32 v43, v37, v37, v43
    v_add_f32 v40, v40, v38
    v_add_f32 v41, v41, v39
    v_fma_f32 v42, v38, v38, v42
    v_fma_f32 v43, v39, v39, v43
    v_lshlrev_b32 v36, 16, v34
    v_and_b32 v37, 0xffff0000, v34
    v_lshlrev_b32 v38, 16, v35
    v_and_b32 v39, 0xffff0000, v35
    v_add_f32 v40, v40, v36
    v_add_f32 v41, v41, v37
    v_fma_f32 v42, v36, v36, v42
    v_fma_f32 v43, v37, v37, v43
    v_add_f32 v40, v40, v38
    v_add_f32 v41, v41, v39
    v_fma_f32 v42, v38, v38, v42
    v_fma_f32 v43, v39, v39, v43
    s_barrier
    v_add_f32 v44, v40, v41
    v_add_f32 v45, v42, v43
    v_mov_b32 v36, v44
    v_mov_b32 v37, v45
    s_nop 1
    v_permlane32_swap_b32 v36, v44
    v_permlane32_swap_b32 v37, v45
    s_nop 1
    v_add_f32 v44, v36, v44
    v_add_f32 v45, v37, v45
    v_mul_f32 v44, 0x3acccccd, v44
    v_mul_f32 v45, 0x3acccccd, v45
    v_fma_f32 v45, -v44, v44, v45
    v_max_f32 v45, 0, v45
    v_cvt_pk_bf16_f32 v44, v44, v45
    v_and_b32 v45, 0xffff0000, v44
    v_lshlrev_b32 v44, 16, v44
    v_add_f32 v45, 0x3727c5ac, v45
    v_cvt_pk_bf16_f32 v45, v45, v45
    v_and_b32 v45, 0xffff0000, v45
    v_sqrt_f32 v45, v45
    v_xor_b32 v44, 0x80000000, v44
    v_cvt_pk_bf16_f32 v45, v45, v45
    v_and_b32 v45, 0xffff0000, v45
    v_rcp_f32 v45, v45
    s_nop 0
    v_and_b32 v58, 31, v0
    s_lshl_b32 s27, s19, 5
    v_add_u32 v58, s27, v58
    v_lshlrev_b32 v59, 2, v58
    v_lshlrev_b32 v60, 3, v58
    s_mov_b64 exec, 0xffffffff
    v_add_u32 v59, 155712, v59
    v_add_u32 v60, 156736, v60
    ds_write_b32 v59, v44
    ds_write_b32 v59, v45 offset:512
    ds_write_b64 v60, v[44:45]
    s_mov_b64 exec, -1
    s_lshl_b32 s27, s19, 6
    v_add_u32 v58, s27, v0
    v_lshlrev_b32 v59, 3, v58
    v_add_u32 v59, 151872, v59
    s_waitcnt lgkmcnt(0)
    s_barrier
    v_cmp_gt_u32 vcc, 160, v58
    s_and_saveexec_b64 s[48:49], vcc
    ds_read_b64 v[20:21], v59 offset:1280
    ds_read_b64 v[22:23], v59 offset:2560
    s_waitcnt lgkmcnt(0)
    v_add_f32 v20, v20, v22
    v_add_f32 v21, v21, v23
    ds_write_b64 v59, v[20:21]
    s_mov_b64 exec, -1
    s_waitcnt lgkmcnt(0)
    s_barrier
    s_cmp_eq_u32 s33, 0
    s_cbranch_scc1 K1_WI_END
    v_lshrrev_b32 v56, 5, v0
    v_lshlrev_b32 v56, 4, v56
    v_bfe_u32 v57, v0, 4, 1
    v_lshlrev_b32 v57, 2, v57
    v_add_u32 v56, v56, v57
    v_bfe_u32 v57, v0, 2, 2
    v_add_u32 v56, v56, v57
    v_mul_u32_u24 v56, 160, v56
    v_add_u32 v56, s20, v56
    v_and_b32 v57, 3, v0
    v_lshlrev_b32 v58, 4, v57
    v_add_u32 v54, v56, v58
    v_lshlrev_b32 v58, 3, v57
    v_add_u32 v55, v56, v58
    v_lshlrev_b32 v53, 4, v0
    s_add_u32 s12, s34, 16777216
    s_addc_u32 s13, s35, 0
    s_mov_b32 s14, 2785280
    s_waitcnt vmcnt(0)
    ds_read_b64_tr_b16 v[56:57], v54 offset:0
    ds_read_b64_tr_b16 v[58:59], v54 offset:1280
    ds_read_b64_tr_b16 v[60:61], v54 offset:8
    ds_read_b64_tr_b16 v[62:63], v54 offset:1288
    ds_read_b64_tr_b16 v[64:65], v54 offset:64
    ds_read_b64_tr_b16 v[66:67], v54 offset:1344
    ds_read_b64_tr_b16 v[68:69], v54 offset:72
    ds_read_b64_tr_b16 v[70:71], v54 offset:1352
    ds_read_b64_tr_b16 v[72:73], v55 offset:128
    ds_read_b64_tr_b16 v[74:75], v55 offset:1408
    s_waitcnt lgkmcnt(0)
    s_add_u32 s27, s54, 0
    buffer_store_dwordx4 v[56:59], v53, s[12:15], s27 offen sc1
    s_add_u32 s27, s54, 1024
    buffer_store_dwordx4 v[60:63], v53, s[12:15], s27 offen sc1
    s_add_u32 s27, s54, 2048
    buffer_store_dwordx4 v[64:67], v53, s[12:15], s27 offen sc1
    s_add_u32 s27, s54, 3072
    buffer_store_dwordx4 v[68:71], v53, s[12:15], s27 offen sc1
    s_add_u32 s27, s54, 4096
    buffer_store_dwordx4 v[72:75], v53, s[12:15], s27 offen sc1
    s_waitcnt vmcnt(0)
K1_WI_END:
K1_END:
    s_endpgm

.globl att_kernel
.p2align 8
.type att_kernel,@function
att_kernel:

    s_cmp_ge_u32 s2, 512
    s_cbranch_scc1 ATT_END
    s_load_dwordx2 s[34:35], s[0:1], 72
    s_cmp_ge_u32 s2, 256
    s_cbranch_scc1 ATT_FFN2
    v_lshrrev_b32 v1, 6, v0
    v_and_b32 v0, 63, v0
    v_readfirstlane_b32 s16, v1
    s_nop 0
    s_cmp_eq_u32 s16, 7
    s_cbranch_scc0 ATT_CPF_END
    s_getpc_b64 s[4:5]
ATT_CPF_PC:
    s_sub_u32 s4, s4, ATT_CPF_PC-att_kernel
    s_subb_u32 s5, s5, 0
    s_mov_b32 s6, FFN_TAIL+4-att_kernel
    s_mov_b32 s7, 0x00020000
    v_lshlrev_b32 v126, 7, v0
    s_lshr_b32 s28, s2, 3
    s_mul_i32 s28, s28, 384
    s_mov_b64 exec, 7
    buffer_load_dword v127, v126, s[4:7], s28 offen
    s_mov_b64 exec, -1
ATT_CPF_END:
    s_and_b32 s27, s2, 7
    s_lshr_b32 s28, s2, 3
    s_and_b32 s29, s28, 0x18
    s_add_u32 s27, s27, s29
    s_and_b32 s28, s28, 7
    s_lshl_b32 s28, s28, 3
    s_add_u32 s28, s28, s16
    s_mul_i32 s29, s27, 81920
    v_and_b32 v1, 31, v0
    v_lshrrev_b32 v2, 5, v0
    v_lshlrev_b32 v5, 3, v1
    v_add_u32 v5, 1024, v5
    v_mul_u32_u24 v6, 320, v2
    v_lshlrev_b32 v1, 4, v1
    v_add_u32 v6, v6, v1
    v_lshlrev_b32 v0, 4, v0
    s_lshl_b32 s20, s16, 10
    s_mov_b32 s17, s20
    s_add_u32 s18, s20, 8192
    s_add_u32 s19, s20, 2619392
    s_cmp_lt_u32 s16, 2
    s_cselect_b32 s18, s18, s19
    s_add_u32 s19, s20, 2627584
    s_mov_b32 s22, 0x000fffff
    s_mov_b32 s23, 0x000fffff
    s_waitcnt lgkmcnt(0)
    s_add_u32 s4, s34, 2621440
    s_addc_u32 s5, s35, 0
    s_add_u32 s4, s4, s29
    s_addc_u32 s5, s5, 0
    s_sub_u32 s6, 5242880, s29
    s_mov_b32 s7, 0x00020000
    s_add_u32 s8, s34, 0
    s_addc_u32 s9, s35, 0
    s_mov_b32 s10, 2621440
    s_mov_b32 s11, 0x00020000
    s_add_u32 s12, s34, 7864320
    s_addc_u32 s13, s35, 0
    s_mov_b32 s14, 2621440
    s_mov_b32 s15, 0x00020000
    s_mul_i32 s33, s28, 1280
    s_add_u32 s33, s33, s29
    v_mov_b32 v12, 0
    v_mov_b32 v13, 0
    v_mov_b32 v14, 0
    v_mov_b32 v15, 0
    buffer_load_dwordx4 v[8:11], v0, s[8:11], s33 offen
    s_mov_b64 exec, 0xffffffff
    buffer_load_dwordx2 v[12:13], v5, s[8:11], s33 offen
    s_mov_b64 exec, -1
    s_mov_b32 s25, 0
    s_mov_b32 s26, 0
    s_add_u32 s30, s17, s25
    s_add_u32 m0, s20, s26
    s_add_u32 s31, s18, s25
    buffer_load_dwordx4 v0, s[4:7], s30 offen lds
    s_add_u32 m0, m0, 8192
    s_add_u32 s30, s19, s25
    buffer_load_dwordx4 v0, s[4:7], s31 offen lds
    s_cmp_ge_u32 s16, 4
    s_cbranch_scc1 L_nodma3_1
    s_add_u32 m0, m0, 8192
    s_nop 0
    buffer_load_dwordx4 v0, s[4:7], s30 offen lds
L_nodma3_1:
    s_mov_b32 s25, 10240
    s_mov_b32 s26, 20480
    s_add_u32 s30, s17, s25
    s_add_u32 m0, s20, s26
    s_add_u32 s31, s18, s25
    buffer_load_dwordx4 v0, s[4:7], s30 offen lds
    s_add_u32 m0, m0, 8192
    s_add_u32 s30, s19, s25
    buffer_load_dwordx4 v0, s[4:7], s31 offen lds
    s_cmp_ge_u32 s16, 4
    s_cbranch_scc1 L_nodma3_2
    s_add_u32 m0, m0, 8192
    s_nop 0
    buffer_load_dwordx4 v0, s[4:7], s30 offen lds
L_nodma3_2:
    v_mov_b32 v22, 0x3f803f80
    v_mov_b32 v23, 0x00003f80
    v_mov_b32 v24, 0x3f803f80
    v_mov_b32 v28, 0x3f803f80
    v_mov_b32 v25, 0x3f803f80
    v_mov_b32 v29, 0x3f803f80
    v_mov_b32 v26, 0x3f803f80
    v_mov_b32 v30, 0x3f803f80
    v_mov_b32 v27, 0x3f803f80
    v_mov_b32 v31, 0x3f803f80
    v_mov_b32 v96, v0
    v_mov_b32 v97, v5
    v_add_u32 v6, 10240, v6
    v_mov_b32 v98, v6
    v_add_u32 v99, 20480, v0
    v_add_u32 v100, 20480, v5
    v_add_u32 v101, 20480, v6
    v_mov_b32 v34, 0
    v_mov_b32 v35, 0
    v_mov_b32 v38, 0
    v_mov_b32 v39, 0
    v_mov_b32 v42, 0
    v_mov_b32 v43, 0
    v_mov_b32 v46, 0
    v_mov_b32 v47, 0
    s_waitcnt vmcnt(2)
    s_barrier
    ds_read_b128 v[16:19], v96 offset:0
    ds_read_b64 v[20:21], v97 offset:0
    s_mov_b64 exec, s[22:23]
    ds_read_b128 v[28:31], v98 offset:640
    ds_read_b128 v[24:27], v98 offset:0
    s_mov_b64 exec, -1
    v_mov_b32 v80, 0
    v_mov_b32 v81, 0
    v_mov_b32 v82, 0
    v_mov_b32 v83, 0
    v_mov_b32 v84, 0
    v_mov_b32 v85, 0
    v_mov_b32 v86, 0
    v_mov_b32 v87, 0
    v_mov_b32 v88, 0
    v_mov_b32 v89, 0
    v_mov_b32 v90, 0
    v_mov_b32 v91, 0
    v_mov_b32 v92, 0
    v_mov_b32 v93, 0
    v_mov_b32 v94, 0
    v_mov_b32 v95, 0
    v_mov_b32 v36, 0
    v_mov_b32 v37, 0
    v_mov_b32 v38, 0
    v_mov_b32 v39, 0
    v_mov_b32 v44, 0
    v_mov_b32 v45, 0
    v_mov_b32 v46, 0
    v_mov_b32 v47, 0
    s_waitcnt lgkmcnt(2)
    v_mfma_f32_32x32x16_bf16 v[64:79], v[16:19], v[8:11], 0
    v_mfma_f32_32x32x16_bf16 v[64:79], v[20:23], v[12:15], v[64:79]
    v_mfma_f32_32x32x16_bf16 v[48:63], v[16:19], v[8:11], 0
    ds_read_b128 v[16:19], v96 offset:1280
    s_nop 7
    s_nop 3
    v_max_f32 v7, v64, v65
    v_max3_f32 v7, v7, v66, v67
    v_max3_f32 v7, v7, v68, v69
    v_max3_f32 v7, v7, v70, v71
    v_max3_f32 v7, v7, v72, v73
    v_max3_f32 v7, v7, v74, v75
    v_max3_f32 v7, v7, v76, v77
    v_max3_f32 v7, v7, v78, v79
    v_mov_b32 v1, v7
    s_nop 1
    v_permlane32_swap_b32 v1, v7
    s_nop 1
    v_max_f32 v7, v1, v7
    v_ceil_f32 v7, v7
    v_mov_b32 v1, 0x42c00000
    v_add_f32 v7, v1, v7
    v_sub_f32 v7, 0, v7
    v_and_b32 v1, 0xffff0000, v7
    v_sub_f32 v2, v7, v1
    v_and_b32 v3, 0xffff0000, v2
    v_sub_f32 v2, v2, v3
    v_lshrrev_b32 v1, 16, v1
    v_or_b32 v1, v1, v3
    v_lshrrev_b32 v2, 16, v2
    s_mov_b64 exec, 0xffffffff
    v_mov_b32 v14, v1
    v_mov_b32 v15, v2
    s_mov_b64 exec, -1
    s_nop 1
    v_mfma_f32_32x32x16_bf16 v[48:63], v[20:23], v[12:15], v[48:63]
    ds_read_b64 v[20:21], v97 offset:1280
    s_waitcnt lgkmcnt(0)
    s_nop 7
    s_nop 7
    s_mov_b32 s24, 0
    s_mov_b32 s25, 20480
    s_mov_b32 s26, 40960
    s_mov_b32 s21, 20480
ATT_LOOP:
    s_waitcnt lgkmcnt(3)
    v_mfma_f32_32x32x16_bf16 v[64:79], v[16:19], v[8:11], 0
    ds_read_b128 v[16:19], v96 offset:2560
    v_cvt_pk_bf16_f32 v38, v44, v45
    v_cvt_pk_bf16_f32 v39, v46, v47
    v_exp_f32 v40, v48
    v_exp_f32 v41, v49
    v_exp_f32 v42, v50
    v_exp_f32 v43, v51
    s_waitcnt lgkmcnt(3)
    v_mfma_f32_32x32x16_bf16 v[64:79], v[20:23], v[12:15], v[64:79]
    ds_read_b64 v[20:21], v97 offset:2560
    v_exp_f32 v44, v52
    v_exp_f32 v45, v53
    v_exp_f32 v46, v54
    v_exp_f32 v47, v55
    v_cvt_pk_bf16_f32 v32, v40, v41
    v_cvt_pk_bf16_f32 v33, v42, v43
    s_waitcnt lgkmcnt(3)
    v_mfma_f32_32x32x16_bf16 v[80:95], v[28:31], v[36:39], v[80:95]
    v_cvt_pk_bf16_f32 v34, v44, v45
    v_cvt_pk_bf16_f32 v35, v46, v47
    v_exp_f32 v40, v56
    v_exp_f32 v41, v57
    v_exp_f32 v42, v58
    v_exp_f32 v43, v59
    s_waitcnt lgkmcnt(2)
    v_mfma_f32_32x32x16_bf16 v[80:95], v[24:27], v[32:35], v[80:95]
    s_mov_b64 exec, s[22:23]
    ds_read_b128 v[28:31], v98 offset:640
    ds_read_b128 v[24:27], v98 offset:1280
    s_mov_b64 exec, -1
    v_exp_f32 v44, v60
    v_exp_f32 v45, v61
    v_exp_f32 v46, v62
    v_exp_f32 v47, v63
    v_cvt_pk_bf16_f32 v36, v40, v41
    v_cvt_pk_bf16_f32 v37, v42, v43
    s_waitcnt lgkmcnt(3)
    v_mfma_f32_32x32x16_bf16 v[48:63], v[16:19], v[8:11], 0
    ds_read_b128 v[16:19], v96 offset:3840
    v_cvt_pk_bf16_f32 v38, v44, v45
    v_cvt_pk_bf16_f32 v39, v46, v47
    v_exp_f32 v40, v64
    v_exp_f32 v41, v65
    v_exp_f32 v42, v66
    v_exp_f32 v43, v67
    s_waitcnt lgkmcnt(3)
    v_mfma_f32_32x32x16_bf16 v[48:63], v[20:23], v[12:15], v[48:63]
    ds_read_b64 v[20:21], v97 offset:3840
    v_exp_f32 v44, v68
    v_exp_f32 v45, v69
    v_exp_f32 v46, v70
    v_exp_f32 v47, v71
    v_cvt_pk_bf16_f32 v32, v40, v41
    v_cvt_pk_bf16_f32 v33, v42, v43
    s_waitcnt lgkmcnt(3)
    v_mfma_f32_32x32x16_bf16 v[80:95], v[28:31], v[36:39], v[80:95]
    v_cvt_pk_bf16_f32 v34, v44, v45
    v_cvt_pk_bf16_f32 v35, v46, v47
    v_exp_f32 v40, v72
    v_exp_f32 v41, v73
    v_exp_f32 v42, v74
    v_exp_f32 v43, v75
    s_waitcnt lgkmcnt(2)
    v_mfma_f32_32x32x16_bf16 v[80:95], v[24:27], v[32:35], v[80:95]
    s_mov_b64 exec, s[22:23]
    ds_read_b128 v[28:31], v98 offset:1920
    ds_read_b128 v[24:27], v98 offset:2560
    s_mov_b64 exec, -1
    v_exp_f32 v44, v76
    v_exp_f32 v45, v77
    v_exp_f32 v46, v78
    v_exp_f32 v47, v79
    v_cvt_pk_bf16_f32 v36, v40, v41
    v_cvt_pk_bf16_f32 v37, v42, v43
    s_waitcnt lgkmcnt(3)
    v_mfma_f32_32x32x16_bf16 v[64:79], v[16:19], v[8:11], 0
    ds_read_b128 v[16:19], v96 offset:5120
    v_cvt_pk_bf16_f32 v38, v44, v45
    v_cvt_pk_bf16_f32 v39, v46, v47
    v_exp_f32 v40, v48
    v_exp_f32 v41, v49
    v_exp_f32 v42, v50
    v_exp_f32 v43, v51
    s_waitcnt lgkmcnt(3)
    v_mfma_f32_32x32x16_bf16 v[64:79], v[20:23], v[12:15], v[64:79]
    ds_read_b64 v[20:21], v97 offset:5120
    v_exp_f32 v44, v52
    v_exp_f32 v45, v53
    v_exp_f32 v46, v54
    v_exp_f32 v47, v55
    v_cvt_pk_bf16_f32 v32, v40, v41
    v_cvt_pk_bf16_f32 v33, v42, v43
    s_waitcnt lgkmcnt(3)
    v_mfma_f32_32x32x16_bf16 v[80:95], v[28:31], v[36:39], v[80:95]
    v_cvt_pk_bf16_f32 v34, v44, v45
    v_cvt_pk_bf16_f32 v35, v46, v47
    v_exp_f32 v40, v56
    v_exp_f32 v41, v57
    v_exp_f32 v42, v58
    v_exp_f32 v43, v59
    s_waitcnt lgkmcnt(2)
    v_mfma_f32_32x32x16_bf16 v[80:95], v[24:27], v[32:35], v[80:95]
    s_mov_b64 exec, s[22:23]
    ds_read_b128 v[28:31], v98 offset:3200
    ds_read_b128 v[24:27], v98 offset:3840
    s_mov_b64 exec, -1
    v_exp_f32 v44, v60
    v_exp_f32 v45, v61
    v_exp_f32 v46, v62
    v_exp_f32 v47, v63
    v_cvt_pk_bf16_f32 v36, v40, v41
    v_cvt_pk_bf16_f32 v37, v42, v43
    s_waitcnt lgkmcnt(3)
    v_mfma_f32_32x32x16_bf16 v[48:63], v[16:19], v[8:11], 0
    ds_read_b128 v[16:19], v96 offset:6400
    v_cvt_pk_bf16_f32 v38, v44, v45
    v_cvt_pk_bf16_f32 v39, v46, v47
    v_exp_f32 v40, v64
    v_exp_f32 v41, v65
    v_exp_f32 v42, v66
    v_exp_f32 v43, v67
    s_waitcnt lgkmcnt(3)
    v_mfma_f32_32x32x16_bf16 v[48:63], v[20:23], v[12:15], v[48:63]
    ds_read_b64 v[20:21], v97 offset:6400
    v_exp_f32 v44, v68
    v_exp_f32 v45, v69
    v_exp_f32 v46, v70
    v_exp_f32 v47, v71
    v_cvt_pk_bf16_f32 v32, v40, v41
    v_cvt_pk_bf16_f32 v33, v42, v43
    s_waitcnt lgkmcnt(3)
    v_mfma_f32_32x32x16_bf16 v[80:95], v[28:31], v[36:39], v[80:95]
    v_cvt_pk_bf16_f32 v34, v44, v45
    v_cvt_pk_bf16_f32 v35, v46, v47
    v_exp_f32 v40, v72
    v_exp_f32 v41, v73
    v_exp_f32 v42, v74
    v_exp_f32 v43, v75
    s_waitcnt lgkmcnt(2)
    v_mfma_f32_32x32x16_bf16 v[80:95], v[24:27], v[32:35], v[80:95]
    s_mov_b64 exec, s[22:23]
    ds_read_b128 v[28:31], v98 offset:4480
    ds_read_b128 v[24:27], v98 offset:5120
    s_mov_b64 exec, -1
    v_exp_f32 v44, v76
    v_exp_f32 v45, v77
    v_exp_f32 v46, v78
    v_exp_f32 v47, v79
    v_cvt_pk_bf16_f32 v36, v40, v41
    v_cvt_pk_bf16_f32 v37, v42, v43
    s_waitcnt lgkmcnt(3)
    v_mfma_f32_32x32x16_bf16 v[64:79], v[16:19], v[8:11], 0
    ds_read_b128 v[16:19], v96 offset:7680
    v_cvt_pk_bf16_f32 v38, v44, v45
    v_cvt_pk_bf16_f32 v39, v46, v47
    v_exp_f32 v40, v48
    v_exp_f32 v41, v49
    v_exp_f32 v42, v50
    v_exp_f32 v43, v51
    s_waitcnt lgkmcnt(3)
    v_mfma_f32_32x32x16_bf16 v[64:79], v[20:23], v[12:15], v[64:79]
    ds_read_b64 v[20:21], v97 offset:7680
    v_exp_f32 v44, v52
    v_exp_f32 v45, v53
    v_exp_f32 v46, v54
    v_exp_f32 v47, v55
    v_cvt_pk_bf16_f32 v32, v40, v41
    v_cvt_pk_bf16_f32 v33, v42, v43
    s_waitcnt lgkmcnt(3)
    v_mfma_f32_32x32x16_bf16 v[80:95], v[28:31], v[36:39], v[80:95]
    v_cvt_pk_bf16_f32 v34, v44, v45
    v_cvt_pk_bf16_f32 v35, v46, v47
    v_exp_f32 v40, v56
    v_exp_f32 v41, v57
    v_exp_f32 v42, v58
    v_exp_f32 v43, v59
    s_waitcnt lgkmcnt(2)
    v_mfma_f32_32x32x16_bf16 v[80:95], v[24:27], v[32:35], v[80:95]
    s_mov_b64 exec, s[22:23]
    ds_read_b128 v[28:31], v98 offset:5760
    ds_read_b128 v[24:27], v98 offset:6400
    s_mov_b64 exec, -1
    v_exp_f32 v44, v60
    v_exp_f32 v45, v61
    v_exp_f32 v46, v62
    v_exp_f32 v47, v63
    v_cvt_pk_bf16_f32 v36, v40, v41
    v_cvt_pk_bf16_f32 v37, v42, v43
    s_waitcnt lgkmcnt(3)
    v_mfma_f32_32x32x16_bf16 v[48:63], v[16:19], v[8:11], 0
    ds_read_b128 v[16:19], v96 offset:8960
    v_cvt_pk_bf16_f32 v38, v44, v45
    v_cvt_pk_bf16_f32 v39, v46, v47
    v_exp_f32 v40, v64
    v_exp_f32 v41, v65
    v_exp_f32 v42, v66
    v_exp_f32 v43, v67
    s_waitcnt lgkmcnt(3)
    v_mfma_f32_32x32x16_bf16 v[48:63], v[20:23], v[12:15], v[48:63]
    ds_read_b64 v[20:21], v97 offset:8960
    v_exp_f32 v44, v68
    v_exp_f32 v45, v69
    v_exp_f32 v46, v70
    v_exp_f32 v47, v71
    v_cvt_pk_bf16_f32 v32, v40, v41
    v_cvt_pk_bf16_f32 v33, v42, v43
    s_waitcnt lgkmcnt(3)
    v_mfma_f32_32x32x16_bf16 v[80:95], v[28:31], v[36:39], v[80:95]
    v_cvt_pk_bf16_f32 v34, v44, v45
    v_cvt_pk_bf16_f32 v35, v46, v47
    v_exp_f32 v40, v72
    v_exp_f32 v41, v73
    v_exp_f32 v42, v74
    v_exp_f32 v43, v75
    s_waitcnt lgkmcnt(2)
    v_mfma_f32_32x32x16_bf16 v[80:95], v[24:27], v[32:35], v[80:95]
    s_mov_b64 exec, s[22:23]
    ds_read_b128 v[28:31], v98 offset:7040
    ds_read_b128 v[24:27], v98 offset:7680
    s_mov_b64 exec, -1
    v_exp_f32 v44, v76
    v_exp_f32 v45, v77
    v_exp_f32 v46, v78
    v_exp_f32 v47, v79
    v_cvt_pk_bf16_f32 v36, v40, v41
    v_cvt_pk_bf16_f32 v37, v42, v43
    s_waitcnt vmcnt(0)
    s_barrier
    s_cmp_ge_u32 s24, 6
    s_cbranch_scc1 L_nodma_3
    s_add_u32 s30, s17, s25
    s_add_u32 m0, s20, s26
    s_add_u32 s31, s18, s25
    buffer_load_dwordx4 v0, s[4:7], s30 offen lds
    s_add_u32 m0, m0, 8192
    s_add_u32 s30, s19, s25
    buffer_load_dwordx4 v0, s[4:7], s31 offen lds
    s_cmp_ge_u32 s16, 4
    s_cbranch_scc1 L_nodma3_4
    s_add_u32 m0, m0, 8192
    s_nop 0
    buffer_load_dwordx4 v0, s[4:7], s30 offen lds
L_nodma3_4:
L_nodma_3:
    s_waitcnt lgkmcnt(3)
    v_mfma_f32_32x32x16_bf16 v[64:79], v[16:19], v[8:11], 0
    ds_read_b128 v[16:19], v99 offset:0
    v_cvt_pk_bf16_f32 v38, v44, v45
    v_cvt_pk_bf16_f32 v39, v46, v47
    v_exp_f32 v40, v48
    v_exp_f32 v41, v49
    v_exp_f32 v42, v50
    v_exp_f32 v43, v51
    s_waitcnt lgkmcnt(3)
    v_mfma_f32_32x32x16_bf16 v[64:79], v[20:23], v[12:15], v[64:79]
    ds_read_b64 v[20:21], v100 offset:0
    v_exp_f32 v44, v52
    v_exp_f32 v45, v53
    v_exp_f32 v46, v54
    v_exp_f32 v47, v55
    v_cvt_pk_bf16_f32 v32, v40, v41
    v_cvt_pk_bf16_f32 v33, v42, v43
    s_waitcnt lgkmcnt(3)
    v_mfma_f32_32x32x16_bf16 v[80:95], v[28:31], v[36:39], v[80:95]
    v_cvt_pk_bf16_f32 v34, v44, v45
    v_cvt_pk_bf16_f32 v35, v46, v47
    v_exp_f32 v40, v56
    v_exp_f32 v41, v57
    v_exp_f32 v42, v58
    v_exp_f32 v43, v59
    s_waitcnt lgkmcnt(2)
    v_mfma_f32_32x32x16_bf16 v[80:95], v[24:27], v[32:35], v[80:95]
    s_mov_b64 exec, s[22:23]
    ds_read_b128 v[28:31], v98 offset:8320
    ds_read_b128 v[24:27], v98 offset:8960
    s_mov_b64 exec, -1
    v_exp_f32 v44, v60
    v_exp_f32 v45, v61
    v_exp_f32 v46, v62
    v_exp_f32 v47, v63
    v_cvt_pk_bf16_f32 v36, v40, v41
    v_cvt_pk_bf16_f32 v37, v42, v43
    s_waitcnt lgkmcnt(3)
    v_mfma_f32_32x32x16_bf16 v[48:63], v[16:19], v[8:11], 0
    ds_read_b128 v[16:19], v99 offset:1280
    v_cvt_pk_bf16_f32 v38, v44, v45
    v_cvt_pk_bf16_f32 v39, v46, v47
    v_exp_f32 v40, v64
    v_exp_f32 v41, v65
    v_exp_f32 v42, v66
    v_exp_f32 v43, v67
    s_waitcnt lgkmcnt(3)
    v_mfma_f32_32x32x16_bf16 v[48:63], v[20:23], v[12:15], v[48:63]
    ds_read_b64 v[20:21], v100 offset:1280
    v_exp_f32 v44, v68
    v_exp_f32 v45, v69
    v_exp_f32 v46, v70
    v_exp_f32 v47, v71
    v_cvt_pk_bf16_f32 v32, v40, v41
    v_cvt_pk_bf16_f32 v33, v42, v43
    s_waitcnt lgkmcnt(3)
    v_mfma_f32_32x32x16_bf16 v[80:95], v[28:31], v[36:39], v[80:95]
    v_cvt_pk_bf16_f32 v34, v44, v45
    v_cvt_pk_bf16_f32 v35, v46, v47
    v_exp_f32 v40, v72
    v_exp_f32 v41, v73
    v_exp_f32 v42, v74
    v_exp_f32 v43, v75
    s_waitcnt lgkmcnt(2)
    v_mfma_f32_32x32x16_bf16 v[80:95], v[24:27], v[32:35], v[80:95]
    s_mov_b64 exec, s[22:23]
    ds_read_b128 v[28:31], v98 offset:9600
    ds_read_b128 v[24:27], v101 offset:0
    s_mov_b64 exec, -1
    v_exp_f32 v44, v76
    v_exp_f32 v45, v77
    v_exp_f32 v46, v78
    v_exp_f32 v47, v79
    v_cvt_pk_bf16_f32 v36, v40, v41
    v_cvt_pk_bf16_f32 v37, v42, v43
    v_mov_b32 v96, v99
    v_mov_b32 v97, v100
    v_mov_b32 v98, v101
    s_mov_b32 s21, s26
    s_add_u32 s26, s26, 20480
    s_cmp_eq_u32 s26, 61440
    s_cselect_b32 s26, 0, s26
    v_add_u32 v99, s21, v0
    v_add_u32 v100, s21, v5
    v_add_u32 v101, s21, v6
    s_add_u32 s25, s25, 10240
    s_add_u32 s24, s24, 1
    s_cmp_lt_u32 s24, 8
    s_cbranch_scc1 ATT_LOOP
    v_cvt_pk_bf16_f32 v38, v44, v45
    v_cvt_pk_bf16_f32 v39, v46, v47
    s_waitcnt lgkmcnt(0)
    s_nop 1
    v_mfma_f32_32x32x16_bf16 v[80:95], v[28:31], v[36:39], v[80:95]
    s_nop 7
    s_nop 7
    v_mov_b32 v1, 0
    v_fma_f32 v1, v80, 0, v1
    v_fma_f32 v1, v81, 0, v1
    v_fma_f32 v1, v82, 0, v1
    v_fma_f32 v1, v83, 0, v1
    v_fma_f32 v1, v84, 0, v1
    v_fma_f32 v1, v85, 0, v1
    v_fma_f32 v1, v86, 0, v1
    v_fma_f32 v1, v87, 0, v1
    v_fma_f32 v1, v88, 0, v1
    v_fma_f32 v1, v89, 0, v1
    v_fma_f32 v1, v90, 0, v1
    v_fma_f32 v1, v91, 0, v1
    v_fma_f32 v1, v92, 0, v1
    v_cmp_u_f32 vcc, v1, v1
    s_mov_b64 s[36:37], vcc
    v_mov_b32 v1, 0x7b800000
    v_cmp_nlt_f32 vcc, v92, v1
    s_or_b64 vcc, vcc, s[36:37]
    s_cbranch_vccnz ATT_FALLBACK
ATT_EPI:
    v_rcp_f32 v1, v92
    s_nop 0
    v_mul_f32 v80, v80, v1
    v_mul_f32 v81, v81, v1
    v_mul_f32 v82, v82, v1
    v_mul_f32 v83, v83, v1
    v_mul_f32 v84, v84, v1
    v_mul_f32 v85, v85, v1
    v_mul_f32 v86, v86, v1
    v_mul_f32 v87, v87, v1
    v_mul_f32 v88, v88, v1
    v_mul_f32 v89, v89, v1
    v_mul_f32 v90, v90, v1
    v_mul_f32 v91, v91, v1
    v_cvt_pk_bf16_f32 v40, v80, v81
    v_cvt_pk_bf16_f32 v41, v82, v83
    v_cvt_pk_bf16_f32 v42, v84, v85
    v_cvt_pk_bf16_f32 v43, v86, v87
    v_cvt_pk_bf16_f32 v44, v88, v89
    v_cvt_pk_bf16_f32 v45, v90, v91
    v_min_u32 v40, -2, v40
    v_min_u32 v41, -2, v41
    v_min_u32 v42, -2, v42
    v_min_u32 v43, -2, v43
    v_min_u32 v44, -2, v44
    v_min_u32 v45, -2, v45
    s_mul_i32 s33, s28, 40960
    s_lshl_b32 s30, s27, 10
    s_add_u32 s30, s30, s33
    buffer_store_dwordx4 v[40:43], v0, s[12:15], s30 offen sc1
    s_lshl_b32 s30, s27, 8
    s_add_u32 s30, s30, s33
    s_add_u32 s30, s30, 31744
    s_mov_b64 exec, 0xffffffff
    buffer_store_dwordx2 v[44:45], v5, s[12:15], s30 offen sc1
    s_waitcnt vmcnt(0)
ATT_END:
    s_endpgm
ATT_FALLBACK:
    v_mov_b32 v14, 0
    v_mov_b32 v15, 0
    v_mov_b32 v7, 0xff800000
    s_mov_b32 s30, 0
ATT_FB1:
    buffer_load_dwordx4 v[16:19], v0, s[4:7], s30 offen
    buffer_load_dwordx2 v[20:21], v5, s[4:7], s30 offen
    s_waitcnt vmcnt(0)
    v_mfma_f32_32x32x16_bf16 v[48:63], v[16:19], v[8:11], 0
    v_mfma_f32_32x32x16_bf16 v[48:63], v[20:23], v[12:15], v[48:63]
    s_nop 7
    s_nop 7
    v_max3_f32 v7, v7, v48, v49
    v_max3_f32 v7, v7, v50, v51
    v_max3_f32 v7, v7, v52, v53
    v_max3_f32 v7, v7, v54, v55
    v_max3_f32 v7, v7, v56, v57
    v_max3_f32 v7, v7, v58, v59
    v_max3_f32 v7, v7, v60, v61
    v_max3_f32 v7, v7, v62, v63
    s_add_u32 s30, s30, 1280
    s_cmp_lt_u32 s30, 81920
    s_cbranch_scc1 ATT_FB1
    v_mov_b32 v1, v7
    s_nop 1
    v_permlane32_swap_b32 v1, v7
    s_nop 1
    v_max_f32 v7, v1, v7
    v_ceil_f32 v7, v7
    v_mov_b32 v1, 0
    v_add_f32 v7, v1, v7
    v_sub_f32 v7, 0, v7
    v_and_b32 v1, 0xffff0000, v7
    v_sub_f32 v2, v7, v1
    v_and_b32 v3, 0xffff0000, v2
    v_sub_f32 v2, v2, v3
    v_lshrrev_b32 v1, 16, v1
    v_or_b32 v1, v1, v3
    v_lshrrev_b32 v2, 16, v2
    s_mov_b64 exec, 0xffffffff
    v_mov_b32 v14, v1
    v_mov_b32 v15, v2
    s_mov_b64 exec, -1
    v_mov_b32 v80, 0
    v_mov_b32 v81, 0
    v_mov_b32 v82, 0
    v_mov_b32 v83, 0
    v_mov_b32 v84, 0
    v_mov_b32 v85, 0
    v_mov_b32 v86, 0
    v_mov_b32 v87, 0
    v_mov_b32 v88, 0
    v_mov_b32 v89, 0
    v_mov_b32 v90, 0
    v_mov_b32 v91, 0
    v_mov_b32 v92, 0
    v_mov_b32 v93, 0
    v_mov_b32 v94, 0
    v_mov_b32 v95, 0
    v_add_u32 v98, 2611200, v6
    s_mov_b32 s30, 0
ATT_FB2:
    buffer_load_dwordx4 v[16:19], v0, s[4:7], s30 offen
    buffer_load_dwordx2 v[20:21], v5, s[4:7], s30 offen
    s_mov_b64 exec, s[22:23]
    buffer_load_dwordx4 v[24:27], v98, s[4:7], s30 offen
    buffer_load_dwordx4 v[28:31], v98, s[4:7], s30 offen offset:640
    s_mov_b64 exec, -1
    s_waitcnt vmcnt(0)
    v_mfma_f32_32x32x16_bf16 v[48:63], v[16:19], v[8:11], 0
    v_mfma_f32_32x32x16_bf16 v[48:63], v[20:23], v[12:15], v[48:63]
    s_nop 7
    s_nop 7
    v_exp_f32 v64, v48
    v_exp_f32 v65, v49
    v_exp_f32 v66, v50
    v_exp_f32 v67, v51
    v_exp_f32 v68, v52
    v_exp_f32 v69, v53
    v_exp_f32 v70, v54
    v_exp_f32 v71, v55
    v_exp_f32 v72, v56
    v_exp_f32 v73, v57
    v_exp_f32 v74, v58
    v_exp_f32 v75, v59
    v_exp_f32 v76, v60
    v_exp_f32 v77, v61
    v_exp_f32 v78, v62
    v_exp_f32 v79, v63
    s_nop 0
    v_cvt_pk_bf16_f32 v32, v64, v65
    v_cvt_pk_bf16_f32 v33, v66, v67
    v_cvt_pk_bf16_f32 v34, v68, v69
    v_cvt_pk_bf16_f32 v35, v70, v71
    v_cvt_pk_bf16_f32 v36, v72, v73
    v_cvt_pk_bf16_f32 v37, v74, v75
    v_cvt_pk_bf16_f32 v38, v76, v77
    v_cvt_pk_bf16_f32 v39, v78, v79
    s_nop 1
    v_mfma_f32_32x32x16_bf16 v[80:95], v[24:27], v[32:35], v[80:95]
    v_mfma_f32_32x32x16_bf16 v[80:95], v[28:31], v[36:39], v[80:95]
    s_add_u32 s30, s30, 1280
    s_cmp_lt_u32 s30, 81920
    s_cbranch_scc1 ATT_FB2
    s_nop 7
    s_nop 7
    s_branch ATT_EPI
ATT_FFN2:
    s_load_dwordx2 s[36:37], s[0:1], 0
    s_load_dwordx2 s[38:39], s[0:1], 56
    v_lshrrev_b32 v3, 6, v0
    v_and_b32 v0, 63, v0
    v_readfirstlane_b32 s16, v3
    s_and_b32 s27, s2, 7
    s_lshr_b32 s28, s2, 3
    s_and_b32 s28, s28, 31
    s_lshr_b32 s29, s27, 1
    s_lshl_b32 s29, s29, 3
    s_lshr_b32 s30, s28, 2
    s_add_u32 s17, s29, s30
    s_and_b32 s27, s27, 1
    s_lshl_b32 s27, s27, 2
    s_and_b32 s28, s28, 3
    s_add_u32 s18, s27, s28
    s_and_b32 s19, s16, 1
    s_lshr_b32 s22, s16, 1
    v_lshrrev_b32 v3, 4, v0
    v_and_b32 v4, 15, v0
    v_lshlrev_b32 v2, 9, v3
    v_lshlrev_b32 v4, 4, v4
    v_add_u32 v2, v2, v4
    v_lshlrev_b32 v0, 4, v0
    v_add_u32 v1, 4096, v0
    s_mul_i32 s27, s18, 348160
    s_mul_i32 s28, s22, 61440
    s_add_u32 s27, s27, s28
    s_add_u32 s27, s27, 16777216
    s_lshl_b32 s28, s17, 1
    s_add_u32 s28, s28, s19
    s_mul_i32 s28, s28, 98304
    s_mul_i32 s29, s22, 24576
    s_add_u32 s28, s28, s29
    s_add_u32 s28, s28, 10485760
    s_mov_b32 s20, 0
    s_mov_b32 s21, 0
    s_waitcnt lgkmcnt(0)
    s_add_u32 s4, s34, s27
    s_addc_u32 s5, s35, 0
    s_mov_b32 s6, 61440
    s_mov_b32 s7, 0x00020000
    s_add_u32 s8, s34, s28
    s_addc_u32 s9, s35, 0
    s_mov_b32 s10, 24576
    s_mov_b32 s11, 0x00020000
    buffer_load_dwordx4 v[24:27], v2, s[8:11], s21 offen offset:0
    buffer_load_dwordx4 v[28:31], v2, s[8:11], s21 offen offset:256
    buffer_load_dwordx4 v[4:7], v0, s[4:7], s20 offen offset:0
    buffer_load_dwordx4 v[8:11], v0, s[4:7], s20 offen offset:1024
    buffer_load_dwordx4 v[12:15], v0, s[4:7], s20 offen offset:2048
    buffer_load_dwordx4 v[16:19], v0, s[4:7], s20 offen offset:3072
    buffer_load_dwordx4 v[20:23], v1, s[4:7], s20 offen
    s_add_u32 s20, s20, 5120
    s_add_u32 s21, s21, 2048
    buffer_load_dwordx4 v[52:55], v2, s[8:11], s21 offen offset:0
    buffer_load_dwordx4 v[56:59], v2, s[8:11], s21 offen offset:256
    buffer_load_dwordx4 v[32:35], v0, s[4:7], s20 offen offset:0
    buffer_load_dwordx4 v[36:39], v0, s[4:7], s20 offen offset:1024
    buffer_load_dwordx4 v[40:43], v0, s[4:7], s20 offen offset:2048
    buffer_load_dwordx4 v[44:47], v0, s[4:7], s20 offen offset:3072
    buffer_load_dwordx4 v[48:51], v1, s[4:7], s20 offen
    s_add_u32 s20, s20, 5120
    s_add_u32 s21, s21, 2048
    buffer_load_dwordx4 v[80:83], v2, s[8:11], s21 offen offset:0
    buffer_load_dwordx4 v[84:87], v2, s[8:11], s21 offen offset:256
    buffer_load_dwordx4 v[60:63], v0, s[4:7], s20 offen offset:0
    buffer_load_dwordx4 v[64:67], v0, s[4:7], s20 offen offset:1024
    buffer_load_dwordx4 v[68:71], v0, s[4:7], s20 offen offset:2048
    buffer_load_dwordx4 v[72:75], v0, s[4:7], s20 offen offset:3072
    buffer_load_dwordx4 v[76:79], v1, s[4:7], s20 offen
    s_add_u32 s20, s20, 5120
    s_add_u32 s21, s21, 2048
    s_waitcnt vmcnt(14)
    v_mfma_f32_16x16x32_bf16 v[88:91], v[4:7], v[24:27], 0
    v_mfma_f32_16x16x32_bf16 v[108:111], v[4:7], v[28:31], 0
    v_mfma_f32_16x16x32_bf16 v[92:95], v[8:11], v[24:27], 0
    v_mfma_f32_16x16x32_bf16 v[112:115], v[8:11], v[28:31], 0
    buffer_load_dwordx4 v[4:7], v0, s[4:7], s20 offen offset:0
    v_mfma_f32_16x16x32_bf16 v[96:99], v[12:15], v[24:27], 0
    v_mfma_f32_16x16x32_bf16 v[116:119], v[12:15], v[28:31], 0
    buffer_load_dwordx4 v[8:11], v0, s[4:7], s20 offen offset:1024
    v_mfma_f32_16x16x32_bf16 v[100:103], v[16:19], v[24:27], 0
    v_mfma_f32_16x16x32_bf16 v[120:123], v[16:19], v[28:31], 0
    buffer_load_dwordx4 v[12:15], v0, s[4:7], s20 offen offset:2048
    v_mfma_f32_16x16x32_bf16 v[104:107], v[20:23], v[24:27], 0
    v_mfma_f32_16x16x32_bf16 v[124:127], v[20:23], v[28:31], 0
    buffer_load_dwordx4 v[16:19], v0, s[4:7], s20 offen offset:3072
    buffer_load_dwordx4 v[20:23], v1, s[4:7], s20 offen
    buffer_load_dwordx4 v[24:27], v2, s[8:11], s21 offen offset:0
    buffer_load_dwordx4 v[28:31], v2, s[8:11], s21 offen offset:256
    s_add_u32 s20, s20, 5120
    s_add_u32 s21, s21, 2048
    s_waitcnt vmcnt(14)
    v_mfma_f32_16x16x32_bf16 v[88:91], v[32:35], v[52:55], v[88:91]
    v_mfma_f32_16x16x32_bf16 v[108:111], v[32:35], v[56:59], v[108:111]
    v_mfma_f32_16x16x32_bf16 v[92:95], v[36:39], v[52:55], v[92:95]
    v_mfma_f32_16x16x32_bf16 v[112:115], v[36:39], v[56:59], v[112:115]
    buffer_load_dwordx4 v[32:35], v0, s[4:7], s20 offen offset:0
    v_mfma_f32_16x16x32_bf16 v[96:99], v[40:43], v[52:55], v[96:99]
    v_mfma_f32_16x16x32_bf16 v[116:119], v[40:43], v[56:59], v[116:119]
    buffer_load_dwordx4 v[36:39], v0, s[4:7], s20 offen offset:1024
    v_mfma_f32_16x16x32_bf16 v[100:103], v[44:47], v[52:55], v[100:103]
    v_mfma_f32_16x16x32_bf16 v[120:123], v[44:47], v[56:59], v[120:123]
    buffer_load_dwordx4 v[40:43], v0, s[4:7], s20 offen offset:2048
    v_mfma_f32_16x16x32_bf16 v[104:107], v[48:51], v[52:55], v[104:107]
    v_mfma_f32_16x16x32_bf16 v[124:127], v[48:51], v[56:59], v[124:127]
    buffer_load_dwordx4 v[44:47], v0, s[4:7], s20 offen offset:3072
    buffer_load_dwordx4 v[48:51], v1, s[4:7], s20 offen
    buffer_load_dwordx4 v[52:55], v2, s[8:11], s21 offen offset:0
    buffer_load_dwordx4 v[56:59], v2, s[8:11], s21 offen offset:256
    s_add_u32 s20, s20, 5120
    s_add_u32 s21, s21, 2048
    s_waitcnt vmcnt(14)
    v_mfma_f32_16x16x32_bf16 v[88:91], v[60:63], v[80:83], v[88:91]
    v_mfma_f32_16x16x32_bf16 v[108:111], v[60:63], v[84:87], v[108:111]
    v_mfma_f32_16x16x32_bf16 v[92:95], v[64:67], v[80:83], v[92:95]
    v_mfma_f32_16x16x32_bf16 v[112:115], v[64:67], v[84:87], v[112:115]
    buffer_load_dwordx4 v[60:63], v0, s[4:7], s20 offen offset:0
    v_mfma_f32_16x16x32_bf16 v[96:99], v[68:71], v[80:83], v[96:99]
    v_mfma_f32_16x16x32_bf16 v[116:119], v[68:71], v[84:87], v[116:119]
    buffer_load_dwordx4 v[64:67], v0, s[4:7], s20 offen offset:1024
    v_mfma_f32_16x16x32_bf16 v[100:103], v[72:75], v[80:83], v[100:103]
    v_mfma_f32_16x16x32_bf16 v[120:123], v[72:75], v[84:87], v[120:123]
    buffer_load_dwordx4 v[68:71], v0, s[4:7], s20 offen offset:2048
    v_mfma_f32_16x16x32_bf16 v[104:107], v[76:79], v[80:83], v[104:107]
    v_mfma_f32_16x16x32_bf16 v[124:127], v[76:79], v[84:87], v[124:127]
    buffer_load_dwordx4 v[72:75], v0, s[4:7], s20 offen offset:3072
    buffer_load_dwordx4 v[76:79], v1, s[4:7], s20 offen
    buffer_load_dwordx4 v[80:83], v2, s[8:11], s21 offen offset:0
    buffer_load_dwordx4 v[84:87], v2, s[8:11], s21 offen offset:256
    s_add_u32 s20, s20, 5120
    s_add_u32 s21, s21, 2048
    s_waitcnt vmcnt(14)
    v_mfma_f32_16x16x32_bf16 v[88:91], v[4:7], v[24:27], v[88:91]
    v_mfma_f32_16x16x32_bf16 v[108:111], v[4:7], v[28:31], v[108:111]
    v_mfma_f32_16x16x32_bf16 v[92:95], v[8:11], v[24:27], v[92:95]
    v_mfma_f32_16x16x32_bf16 v[112:115], v[8:11], v[28:31], v[112:115]
    buffer_load_dwordx4 v[4:7], v0, s[4:7], s20 offen offset:0
    v_mfma_f32_16x16x32_bf16 v[96:99], v[12:15], v[24:27], v[96:99]
    v_mfma_f32_16x16x32_bf16 v[116:119], v[12:15], v[28:31], v[116:119]
    buffer_load_dwordx4 v[8:11], v0, s[4:7], s20 offen offset:1024
    v_mfma_f32_16x16x32_bf16 v[100:103], v[16:19], v[24:27], v[100:103]
    v_mfma_f32_16x16x32_bf16 v[120:123], v[16:19], v[28:31], v[120:123]
    buffer_load_dwordx4 v[12:15], v0, s[4:7], s20 offen offset:2048
    v_mfma_f32_16x16x32_bf16 v[104:107], v[20:23], v[24:27], v[104:107]
    v_mfma_f32_16x16x32_bf16 v[124:127], v[20:23], v[28:31], v[124:127]
    buffer_load_dwordx4 v[16:19], v0, s[4:7], s20 offen offset:3072
    buffer_load_dwordx4 v[20:23], v1, s[4:7], s20 offen
    buffer_load_dwordx4 v[24:27], v2, s[8:11], s21 offen offset:0
    buffer_load_dwordx4 v[28:31], v2, s[8:11], s21 offen offset:256
    s_add_u32 s20, s20, 5120
    s_add_u32 s21, s21, 2048
    s_waitcnt vmcnt(14)
    v_mfma_f32_16x16x32_bf16 v[88:91], v[32:35], v[52:55], v[88:91]
    v_mfma_f32_16x16x32_bf16 v[108:111], v[32:35], v[56:59], v[108:111]
    v_mfma_f32_16x16x32_bf16 v[92:95], v[36:39], v[52:55], v[92:95]
    v_mfma_f32_16x16x32_bf16 v[112:115], v[36:39], v[56:59], v[112:115]
    buffer_load_dwordx4 v[32:35], v0, s[4:7], s20 offen offset:0
    v_mfma_f32_16x16x32_bf16 v[96:99], v[40:43], v[52:55], v[96:99]
    v_mfma_f32_16x16x32_bf16 v[116:119], v[40:43], v[56:59], v[116:119]
    buffer_load_dwordx4 v[36:39], v0, s[4:7], s20 offen offset:1024
    v_mfma_f32_16x16x32_bf16 v[100:103], v[44:47], v[52:55], v[100:103]
    v_mfma_f32_16x16x32_bf16 v[120:123], v[44:47], v[56:59], v[120:123]
    buffer_load_dwordx4 v[40:43], v0, s[4:7], s20 offen offset:2048
    v_mfma_f32_16x16x32_bf16 v[104:107], v[48:51], v[52:55], v[104:107]
    v_mfma_f32_16x16x32_bf16 v[124:127], v[48:51], v[56:59], v[124:127]
    buffer_load_dwordx4 v[44:47], v0, s[4:7], s20 offen offset:3072
    buffer_load_dwordx4 v[48:51], v1, s[4:7], s20 offen
    buffer_load_dwordx4 v[52:55], v2, s[8:11], s21 offen offset:0
    buffer_load_dwordx4 v[56:59], v2, s[8:11], s21 offen offset:256
    s_add_u32 s20, s20, 5120
    s_add_u32 s21, s21, 2048
    s_waitcnt vmcnt(14)
    v_mfma_f32_16x16x32_bf16 v[88:91], v[60:63], v[80:83], v[88:91]
    v_mfma_f32_16x16x32_bf16 v[108:111], v[60:63], v[84:87], v[108:111]
    v_mfma_f32_16x16x32_bf16 v[92:95], v[64:67], v[80:83], v[92:95]
    v_mfma_f32_16x16x32_bf16 v[112:115], v[64:67], v[84:87], v[112:115]
    buffer_load_dwordx4 v[60:63], v0, s[4:7], s20 offen offset:0
    v_mfma_f32_16x16x32_bf16 v[96:99], v[68:71], v[80:83], v[96:99]
    v_mfma_f32_16x16x32_bf16 v[116:119], v[68:71], v[84:87], v[116:119]
    buffer_load_dwordx4 v[64:67], v0, s[4:7], s20 offen offset:1024
    v_mfma_f32_16x16x32_bf16 v[100:103], v[72:75], v[80:83], v[100:103]
    v_mfma_f32_16x16x32_bf16 v[120:123], v[72:75], v[84:87], v[120:123]
    buffer_load_dwordx4 v[68:71], v0, s[4:7], s20 offen offset:2048
    v_mfma_f32_16x16x32_bf16 v[104:107], v[76:79], v[80:83], v[104:107]
    v_mfma_f32_16x16x32_bf16 v[124:127], v[76:79], v[84:87], v[124:127]
    buffer_load_dwordx4 v[72:75], v0, s[4:7], s20 offen offset:3072
    buffer_load_dwordx4 v[76:79], v1, s[4:7], s20 offen
    buffer_load_dwordx4 v[80:83], v2, s[8:11], s21 offen offset:0
    buffer_load_dwordx4 v[84:87], v2, s[8:11], s21 offen offset:256
    s_add_u32 s20, s20, 5120
    s_add_u32 s21, s21, 2048
    s_waitcnt vmcnt(14)
    v_mfma_f32_16x16x32_bf16 v[88:91], v[4:7], v[24:27], v[88:91]
    v_mfma_f32_16x16x32_bf16 v[108:111], v[4:7], v[28:31], v[108:111]
    v_mfma_f32_16x16x32_bf16 v[92:95], v[8:11], v[24:27], v[92:95]
    v_mfma_f32_16x16x32_bf16 v[112:115], v[8:11], v[28:31], v[112:115]
    buffer_load_dwordx4 v[4:7], v0, s[4:7], s20 offen offset:0
    v_mfma_f32_16x16x32_bf16 v[96:99], v[12:15], v[24:27], v[96:99]
    v_mfma_f32_16x16x32_bf16 v[116:119], v[12:15], v[28:31], v[116:119]
    buffer_load_dwordx4 v[8:11], v0, s[4:7], s20 offen offset:1024
    v_mfma_f32_16x16x32_bf16 v[100:103], v[16:19], v[24:27], v[100:103]
    v_mfma_f32_16x16x32_bf16 v[120:123], v[16:19], v[28:31], v[120:123]
    buffer_load_dwordx4 v[12:15], v0, s[4:7], s20 offen offset:2048
    v_mfma_f32_16x16x32_bf16 v[104:107], v[20:23], v[24:27], v[104:107]
    v_mfma_f32_16x16x32_bf16 v[124:127], v[20:23], v[28:31], v[124:127]
    buffer_load_dwordx4 v[16:19], v0, s[4:7], s20 offen offset:3072
    buffer_load_dwordx4 v[20:23], v1, s[4:7], s20 offen
    buffer_load_dwordx4 v[24:27], v2, s[8:11], s21 offen offset:0
    buffer_load_dwordx4 v[28:31], v2, s[8:11], s21 offen offset:256
    s_add_u32 s20, s20, 5120
    s_add_u32 s21, s21, 2048
    s_waitcnt vmcnt(14)
    v_mfma_f32_16x16x32_bf16 v[88:91], v[32:35], v[52:55], v[88:91]
    v_mfma_f32_16x16x32_bf16 v[108:111], v[32:35], v[56:59], v[108:111]
    v_mfma_f32_16x16x32_bf16 v[92:95], v[36:39], v[52:55], v[92:95]
    v_mfma_f32_16x16x32_bf16 v[112:115], v[36:39], v[56:59], v[112:115]
    buffer_load_dwordx4 v[32:35], v0, s[4:7], s20 offen offset:0
    v_mfma_f32_16x16x32_bf16 v[96:99], v[40:43], v[52:55], v[96:99]
    v_mfma_f32_16x16x32_bf16 v[116:119], v[40:43], v[56:59], v[116:119]
    buffer_load_dwordx4 v[36:39], v0, s[4:7], s20 offen offset:1024
    v_mfma_f32_16x16x32_bf16 v[100:103], v[44:47], v[52:55], v[100:103]
    v_mfma_f32_16x16x32_bf16 v[120:123], v[44:47], v[56:59], v[120:123]
    buffer_load_dwordx4 v[40:43], v0, s[4:7], s20 offen offset:2048
    v_mfma_f32_16x16x32_bf16 v[104:107], v[48:51], v[52:55], v[104:107]
    v_mfma_f32_16x16x32_bf16 v[124:127], v[48:51], v[56:59], v[124:127]
    buffer_load_dwordx4 v[44:47], v0, s[4:7], s20 offen offset:3072
    buffer_load_dwordx4 v[48:51], v1, s[4:7], s20 offen
    buffer_load_dwordx4 v[52:55], v2, s[8:11], s21 offen offset:0
    buffer_load_dwordx4 v[56:59], v2, s[8:11], s21 offen offset:256
    s_add_u32 s20, s20, 5120
    s_add_u32 s21, s21, 2048
    s_waitcnt vmcnt(14)
    v_mfma_f32_16x16x32_bf16 v[88:91], v[60:63], v[80:83], v[88:91]
    v_mfma_f32_16x16x32_bf16 v[108:111], v[60:63], v[84:87], v[108:111]
    v_mfma_f32_16x16x32_bf16 v[92:95], v[64:67], v[80:83], v[92:95]
    v_mfma_f32_16x16x32_bf16 v[112:115], v[64:67], v[84:87], v[112:115]
    buffer_load_dwordx4 v[60:63], v0, s[4:7], s20 offen offset:0
    v_mfma_f32_16x16x32_bf16 v[96:99], v[68:71], v[80:83], v[96:99]
    v_mfma_f32_16x16x32_bf16 v[116:119], v[68:71], v[84:87], v[116:119]
    buffer_load_dwordx4 v[64:67], v0, s[4:7], s20 offen offset:1024
    v_mfma_f32_16x16x32_bf16 v[100:103], v[72:75], v[80:83], v[100:103]
    v_mfma_f32_16x16x32_bf16 v[120:123], v[72:75], v[84:87], v[120:123]
    buffer_load_dwordx4 v[68:71], v0, s[4:7], s20 offen offset:2048
    v_mfma_f32_16x16x32_bf16 v[104:107], v[76:79], v[80:83], v[104:107]
    v_mfma_f32_16x16x32_bf16 v[124:127], v[76:79], v[84:87], v[124:127]
    buffer_load_dwordx4 v[72:75], v0, s[4:7], s20 offen offset:3072
    buffer_load_dwordx4 v[76:79], v1, s[4:7], s20 offen
    buffer_load_dwordx4 v[80:83], v2, s[8:11], s21 offen offset:0
    buffer_load_dwordx4 v[84:87], v2, s[8:11], s21 offen offset:256
    s_add_u32 s20, s20, 5120
    s_add_u32 s21, s21, 2048
    s_waitcnt vmcnt(14)
    v_mfma_f32_16x16x32_bf16 v[88:91], v[4:7], v[24:27], v[88:91]
    v_mfma_f32_16x16x32_bf16 v[108:111], v[4:7], v[28:31], v[108:111]
    v_mfma_f32_16x16x32_bf16 v[92:95], v[8:11], v[24:27], v[92:95]
    v_mfma_f32_16x16x32_bf16 v[112:115], v[8:11], v[28:31], v[112:115]
    v_mfma_f32_16x16x32_bf16 v[96:99], v[12:15], v[24:27], v[96:99]
    v_mfma_f32_16x16x32_bf16 v[116:119], v[12:15], v[28:31], v[116:119]
    v_mfma_f32_16x16x32_bf16 v[100:103], v[16:19], v[24:27], v[100:103]
    v_mfma_f32_16x16x32_bf16 v[120:123], v[16:19], v[28:31], v[120:123]
    v_mfma_f32_16x16x32_bf16 v[104:107], v[20:23], v[24:27], v[104:107]
    v_mfma_f32_16x16x32_bf16 v[124:127], v[20:23], v[28:31], v[124:127]
    s_waitcnt vmcnt(7)
    v_mfma_f32_16x16x32_bf16 v[88:91], v[32:35], v[52:55], v[88:91]
    v_mfma_f32_16x16x32_bf16 v[108:111], v[32:35], v[56:59], v[108:111]
    v_mfma_f32_16x16x32_bf16 v[92:95], v[36:39], v[52:55], v[92:95]
    v_mfma_f32_16x16x32_bf16 v[112:115], v[36:39], v[56:59], v[112:115]
    v_mfma_f32_16x16x32_bf16 v[96:99], v[40:43], v[52:55], v[96:99]
    v_mfma_f32_16x16x32_bf16 v[116:119], v[40:43], v[56:59], v[116:119]
    v_mfma_f32_16x16x32_bf16 v[100:103], v[44:47], v[52:55], v[100:103]
    v_mfma_f32_16x16x32_bf16 v[120:123], v[44:47], v[56:59], v[120:123]
    v_mfma_f32_16x16x32_bf16 v[104:107], v[48:51], v[52:55], v[104:107]
    v_mfma_f32_16x16x32_bf16 v[124:127], v[48:51], v[56:59], v[124:127]
    s_waitcnt vmcnt(0)
    v_mfma_f32_16x16x32_bf16 v[88:91], v[60:63], v[80:83], v[88:91]
    v_mfma_f32_16x16x32_bf16 v[108:111], v[60:63], v[84:87], v[108:111]
    v_mfma_f32_16x16x32_bf16 v[92:95], v[64:67], v[80:83], v[92:95]
    v_mfma_f32_16x16x32_bf16 v[112:115], v[64:67], v[84:87], v[112:115]
    v_mfma_f32_16x16x32_bf16 v[96:99], v[68:71], v[80:83], v[96:99]
    v_mfma_f32_16x16x32_bf16 v[116:119], v[68:71], v[84:87], v[116:119]
    v_mfma_f32_16x16x32_bf16 v[100:103], v[72:75], v[80:83], v[100:103]
    v_mfma_f32_16x16x32_bf16 v[120:123], v[72:75], v[84:87], v[120:123]
    v_mfma_f32_16x16x32_bf16 v[104:107], v[76:79], v[80:83], v[104:107]
    v_mfma_f32_16x16x32_bf16 v[124:127], v[76:79], v[84:87], v[124:127]
    s_lshl_b32 s23, s19, 1
    s_add_u32 s27, s23, 0
    s_mul_i32 s27, s27, 3
    s_cmp_gt_u32 s22, 0
    s_cselect_b32 s28, 1, 0
    s_sub_u32 s28, s22, s28
    s_add_u32 s27, s27, s28
    s_mul_i32 s27, s27, 5120
    v_add_u32 v4, s27, v0
    s_add_u32 s27, s23, 1
    s_mul_i32 s27, s27, 3
    s_cmp_gt_u32 s22, 1
    s_cselect_b32 s28, 1, 0
    s_sub_u32 s28, s22, s28
    s_add_u32 s27, s27, s28
    s_mul_i32 s27, s27, 5120
    v_add_u32 v5, s27, v0
    s_nop 7
    s_cmp_eq_u32 s22, 0
    s_cbranch_scc1 L_fx_5
    ds_write_b128 v4, v[88:91] offset:0
    ds_write_b128 v4, v[92:95] offset:1024
    ds_write_b128 v4, v[96:99] offset:2048
    ds_write_b128 v4, v[100:103] offset:3072
    ds_write_b128 v4, v[104:107] offset:4096
L_fx_5:
    s_cmp_eq_u32 s22, 1
    s_cbranch_scc1 L_fx_6
    ds_write_b128 v5, v[108:111] offset:0
    ds_write_b128 v5, v[112:115] offset:1024
    ds_write_b128 v5, v[116:119] offset:2048
    ds_write_b128 v5, v[120:123] offset:3072
    ds_write_b128 v5, v[124:127] offset:4096
L_fx_6:
    s_waitcnt lgkmcnt(0)
    s_barrier
    s_and_b32 s24, s22, 1
    s_add_u32 s24, s23, s24
    s_lshl_b32 s27, s17, 6
    s_lshl_b32 s28, s24, 4
    s_add_u32 s27, s27, s28
    s_mul_i32 s27, s27, 1280
    s_mul_i32 s28, s18, 160
    s_add_u32 s26, s27, s28
    s_mov_b32 s12, s36
    s_mov_b32 s13, s37
    s_mov_b32 s14, 2621440
    s_mov_b32 s15, 0x00020000
    s_cmp_ge_u32 s22, 2
    s_cbranch_scc1 FFN_NOG
    s_mul_i32 s27, s24, 15360
    v_add_u32 v3, s27, v0
    ds_read_b128 v[4:7], v3 offset:0
    ds_read_b128 v[8:11], v3 offset:1024
    ds_read_b128 v[12:15], v3 offset:2048
    ds_read_b128 v[16:19], v3 offset:3072
    ds_read_b128 v[20:23], v3 offset:4096
    ds_read_b128 v[24:27], v3 offset:5120
    ds_read_b128 v[28:31], v3 offset:6144
    ds_read_b128 v[32:35], v3 offset:7168
    ds_read_b128 v[36:39], v3 offset:8192
    ds_read_b128 v[40:43], v3 offset:9216
    ds_read_b128 v[44:47], v3 offset:10240
    ds_read_b128 v[48:51], v3 offset:11264
    ds_read_b128 v[52:55], v3 offset:12288
    ds_read_b128 v[56:59], v3 offset:13312
    ds_read_b128 v[60:63], v3 offset:14336
    s_cmp_eq_u32 s22, 0
    s_cbranch_scc1 FFN_OWN0
    v_mov_b32 v88, v108
    v_mov_b32 v89, v109
    v_mov_b32 v90, v110
    v_mov_b32 v91, v111
    v_mov_b32 v92, v112
    v_mov_b32 v93, v113
    v_mov_b32 v94, v114
    v_mov_b32 v95, v115
    v_mov_b32 v96, v116
    v_mov_b32 v97, v117
    v_mov_b32 v98, v118
    v_mov_b32 v99, v119
    v_mov_b32 v100, v120
    v_mov_b32 v101, v121
    v_mov_b32 v102, v122
    v_mov_b32 v103, v123
    v_mov_b32 v104, v124
    v_mov_b32 v105, v125
    v_mov_b32 v106, v126
    v_mov_b32 v107, v127
FFN_OWN0:
    s_waitcnt lgkmcnt(10)
    v_add_f32 v88, v88, v4
    v_add_f32 v89, v89, v5
    v_add_f32 v90, v90, v6
    v_add_f32 v91, v91, v7
    v_add_f32 v92, v92, v8
    v_add_f32 v93, v93, v9
    v_add_f32 v94, v94, v10
    v_add_f32 v95, v95, v11
    v_add_f32 v96, v96, v12
    v_add_f32 v97, v97, v13
    v_add_f32 v98, v98, v14
    v_add_f32 v99, v99, v15
    v_add_f32 v100, v100, v16
    v_add_f32 v101, v101, v17
    v_add_f32 v102, v102, v18
    v_add_f32 v103, v103, v19
    v_add_f32 v104, v104, v20
    v_add_f32 v105, v105, v21
    v_add_f32 v106, v106, v22
    v_add_f32 v107, v107, v23
    s_waitcnt lgkmcnt(5)
    v_add_f32 v88, v88, v24
    v_add_f32 v89, v89, v25
    v_add_f32 v90, v90, v26
    v_add_f32 v91, v91, v27
    v_add_f32 v92, v92, v28
    v_add_f32 v93, v93, v29
    v_add_f32 v94, v94, v30
    v_add_f32 v95, v95, v31
    v_add_f32 v96, v96, v32
    v_add_f32 v97, v97, v33
    v_add_f32 v98, v98, v34
    v_add_f32 v99, v99, v35
    v_add_f32 v100, v100, v36
    v_add_f32 v101, v101, v37
    v_add_f32 v102, v102, v38
    v_add_f32 v103, v103, v39
    v_add_f32 v104, v104, v40
    v_add_f32 v105, v105, v41
    v_add_f32 v106, v106, v42
    v_add_f32 v107, v107, v43
    s_waitcnt lgkmcnt(0)
    v_add_f32 v88, v88, v44
    v_add_f32 v89, v89, v45
    v_add_f32 v90, v90, v46
    v_add_f32 v91, v91, v47
    v_add_f32 v92, v92, v48
    v_add_f32 v93, v93, v49
    v_add_f32 v94, v94, v50
    v_add_f32 v95, v95, v51
    v_add_f32 v96, v96, v52
    v_add_f32 v97, v97, v53
    v_add_f32 v98, v98, v54
    v_add_f32 v99, v99, v55
    v_add_f32 v100, v100, v56
    v_add_f32 v101, v101, v57
    v_add_f32 v102, v102, v58
    v_add_f32 v103, v103, v59
    v_add_f32 v104, v104, v60
    v_add_f32 v105, v105, v61
    v_add_f32 v106, v106, v62
    v_add_f32 v107, v107, v63
    v_mul_f32 v108, 0xbfb8aa3b, v88
    v_mul_f32 v109, 0xbfb8aa3b, v89
    v_mul_f32 v110, 0xbfb8aa3b, v90
    v_mul_f32 v111, 0xbfb8aa3b, v91
    v_mul_f32 v112, 0xbfb8aa3b, v92
    v_mul_f32 v113, 0xbfb8aa3b, v93
    v_mul_f32 v114, 0xbfb8aa3b, v94
    v_mul_f32 v115, 0xbfb8aa3b, v95
    v_mul_f32 v116, 0xbfb8aa3b, v96
    v_mul_f32 v117, 0xbfb8aa3b, v97
    v_mul_f32 v118, 0xbfb8aa3b, v98
    v_mul_f32 v119, 0xbfb8aa3b, v99
    v_mul_f32 v120, 0xbfb8aa3b, v100
    v_mul_f32 v121, 0xbfb8aa3b, v101
    v_mul_f32 v122, 0xbfb8aa3b, v102
    v_mul_f32 v123, 0xbfb8aa3b, v103
    v_mul_f32 v124, 0xbfb8aa3b, v104
    v_mul_f32 v125, 0xbfb8aa3b, v105
    v_mul_f32 v126, 0xbfb8aa3b, v106
    v_mul_f32 v127, 0xbfb8aa3b, v107
    v_exp_f32 v108, v108
    v_exp_f32 v109, v109
    v_exp_f32 v110, v110
    v_exp_f32 v111, v111
    v_exp_f32 v112, v112
    v_exp_f32 v113, v113
    v_exp_f32 v114, v114
    v_exp_f32 v115, v115
    v_exp_f32 v116, v116
    v_exp_f32 v117, v117
    v_exp_f32 v118, v118
    v_exp_f32 v119, v119
    v_exp_f32 v120, v120
    v_exp_f32 v121, v121
    v_exp_f32 v122, v122
    v_exp_f32 v123, v123
    v_exp_f32 v124, v124
    v_exp_f32 v125, v125
    v_exp_f32 v126, v126
    v_exp_f32 v127, v127
    v_add_f32 v108, 1.0, v108
    v_add_f32 v109, 1.0, v109
    v_add_f32 v110, 1.0, v110
    v_add_f32 v111, 1.0, v111
    v_add_f32 v112, 1.0, v112
    v_add_f32 v113, 1.0, v113
    v_add_f32 v114, 1.0, v114
    v_add_f32 v115, 1.0, v115
    v_add_f32 v116, 1.0, v116
    v_add_f32 v117, 1.0, v117
    v_add_f32 v118, 1.0, v118
    v_add_f32 v119, 1.0, v119
    v_add_f32 v120, 1.0, v120
    v_add_f32 v121, 1.0, v121
    v_add_f32 v122, 1.0, v122
    v_add_f32 v123, 1.0, v123
    v_add_f32 v124, 1.0, v124
    v_add_f32 v125, 1.0, v125
    v_add_f32 v126, 1.0, v126
    v_add_f32 v127, 1.0, v127
    v_rcp_f32 v108, v108
    v_rcp_f32 v109, v109
    v_rcp_f32 v110, v110
    v_rcp_f32 v111, v111
    v_rcp_f32 v112, v112
    v_rcp_f32 v113, v113
    v_rcp_f32 v114, v114
    v_rcp_f32 v115, v115
    v_rcp_f32 v116, v116
    v_rcp_f32 v117, v117
    v_rcp_f32 v118, v118
    v_rcp_f32 v119, v119
    v_rcp_f32 v120, v120
    v_rcp_f32 v121, v121
    v_rcp_f32 v122, v122
    v_rcp_f32 v123, v123
    v_rcp_f32 v124, v124
    v_rcp_f32 v125, v125
    v_rcp_f32 v126, v126
    v_rcp_f32 v127, v127
    v_mul_f32 v88, v88, v108
    v_mul_f32 v89, v89, v109
    v_mul_f32 v90, v90, v110
    v_mul_f32 v91, v91, v111
    v_mul_f32 v92, v92, v112
    v_mul_f32 v93, v93, v113
    v_mul_f32 v94, v94, v114
    v_mul_f32 v95, v95, v115
    v_mul_f32 v96, v96, v116
    v_mul_f32 v97, v97, v117
    v_mul_f32 v98, v98, v118
    v_mul_f32 v99, v99, v119
    v_mul_f32 v100, v100, v120
    v_mul_f32 v101, v101, v121
    v_mul_f32 v102, v102, v122
    v_mul_f32 v103, v103, v123
    v_mul_f32 v104, v104, v124
    v_mul_f32 v105, v105, v125
    v_mul_f32 v106, v106, v126
    v_mul_f32 v107, v107, v127
    v_cvt_pk_bf16_f32 v108, v88, v89
    v_cvt_pk_bf16_f32 v109, v90, v91
    v_cvt_pk_bf16_f32 v110, v92, v93
    v_cvt_pk_bf16_f32 v111, v94, v95
    v_cvt_pk_bf16_f32 v112, v96, v97
    v_cvt_pk_bf16_f32 v113, v98, v99
    v_cvt_pk_bf16_f32 v114, v100, v101
    v_cvt_pk_bf16_f32 v115, v102, v103
    v_cvt_pk_bf16_f32 v116, v104, v105
    v_cvt_pk_bf16_f32 v117, v106, v107
    v_bfe_u32 v64, v0, 4, 4
    v_lshrrev_b32 v65, 8, v0
    v_mul_u32_u24 v64, 1280, v64
    v_lshlrev_b32 v65, 3, v65
    v_add_u32 v3, v64, v65
    v_add_u32 v64, v3, v65
    v_add_u32 v65, 128, v3
    buffer_load_dwordx4 v[118:121], v64, s[12:15], s26 offen
    buffer_load_dwordx4 v[122:125], v64, s[12:15], s26 offen offset:64
    buffer_load_dwordx2 v[126:127], v65, s[12:15], s26 offen
FFN_NOG:
    v_bfe_u32 v64, v0, 4, 4
    v_lshrrev_b32 v65, 8, v0
    v_mul_u32_u24 v64, 1280, v64
    v_lshlrev_b32 v65, 3, v65
    v_add_u32 v3, v64, v65
    v_add_u32 v64, v3, v65
    v_add_u32 v65, 128, v3
    s_mul_i32 s27, s18, 348160
    s_mul_i32 s28, s22, 20480
    s_add_u32 s27, s27, s28
    s_add_u32 s27, s27, 17022976
    s_add_u32 s4, s34, s27
    s_addc_u32 s5, s35, 0
    s_sub_u32 s6, 102400, s28
    buffer_load_dwordx4 v[44:47], v0, s[4:7], 0 offen offset:0
    buffer_load_dwordx4 v[48:51], v0, s[4:7], 0 offen offset:1024
    buffer_load_dwordx4 v[52:55], v0, s[4:7], 0 offen offset:2048
    buffer_load_dwordx4 v[56:59], v0, s[4:7], 0 offen offset:3072
    buffer_load_dwordx4 v[60:63], v1, s[4:7], 0 offen
    s_mul_i32 s27, s22, 20480
    v_add_u32 v66, s27, v0
    s_mul_i32 s28, s19, 10240
    s_add_u32 s27, s27, s28
    s_add_u32 s28, s28, 5120
    s_mul_i32 s33, s22, 15360
    s_sub_u32 s33, 81920, s33
    s_cmp_eq_u32 s19, 0
    s_cselect_b32 s33, 10240, s33
    s_barrier
    s_mov_b32 m0, s27
    s_add_u32 s27, s27, 1024
    buffer_load_dwordx4 v0, s[4:7], s28 offen lds
    s_add_u32 s28, s28, 1024
    s_mov_b32 m0, s27
    s_add_u32 s27, s27, 1024
    buffer_load_dwordx4 v0, s[4:7], s28 offen lds
    s_add_u32 s28, s28, 1024
    s_mov_b32 m0, s27
    s_add_u32 s27, s27, 1024
    buffer_load_dwordx4 v0, s[4:7], s28 offen lds
    s_add_u32 s28, s28, 1024
    s_mov_b32 m0, s27
    s_add_u32 s27, s27, 1024
    buffer_load_dwordx4 v0, s[4:7], s28 offen lds
    s_add_u32 s28, s28, 1024
    s_mov_b32 m0, s27
    s_add_u32 s27, s27, 1024
    buffer_load_dwordx4 v0, s[4:7], s28 offen lds
    s_add_u32 s28, s28, 1024
    s_mov_b32 s28, s33
    s_mov_b32 m0, s27
    s_add_u32 s27, s27, 1024
    buffer_load_dwordx4 v0, s[4:7], s28 offen lds
    s_add_u32 s28, s28, 1024
    s_mov_b32 m0, s27
    s_add_u32 s27, s27, 1024
    buffer_load_dwordx4 v0, s[4:7], s28 offen lds
    s_add_u32 s28, s28, 1024
    s_mov_b32 m0, s27
    s_add_u32 s27, s27, 1024
    buffer_load_dwordx4 v0, s[4:7], s28 offen lds
    s_add_u32 s28, s28, 1024
    s_mov_b32 m0, s27
    s_add_u32 s27, s27, 1024
    buffer_load_dwordx4 v0, s[4:7], s28 offen lds
    s_add_u32 s28, s28, 1024
    s_mov_b32 m0, s27
    s_add_u32 s27, s27, 1024
    buffer_load_dwordx4 v0, s[4:7], s28 offen lds
    s_add_u32 s28, s28, 1024
    s_lshl_b32 s28, s17, 1
    s_add_u32 s28, s28, s19
    s_mul_i32 s28, s28, 40960
    s_lshl_b32 s29, s22, 13
    s_add_u32 s28, s28, s29
    s_add_u32 s28, s28, 7864320
    s_add_u32 s8, s34, s28
    s_addc_u32 s9, s35, 0
    s_sub_u32 s10, 40960, s29
    s_mul_i32 s33, s22, 6144
    s_sub_u32 s33, 32768, s33
    s_add_u32 s27, s23, 0
    s_mul_i32 s27, s27, 3
    s_cmp_gt_u32 s22, 0
    s_cselect_b32 s28, 1, 0
    s_sub_u32 s28, s22, s28
    s_add_u32 s27, s27, s28
    s_mul_i32 s27, s27, 5120
    v_add_u32 v1, s27, v0
    s_add_u32 s27, s23, 1
    s_mul_i32 s27, s27, 3
    s_cmp_gt_u32 s22, 1
    s_cselect_b32 s28, 1, 0
    s_sub_u32 s28, s22, s28
    s_add_u32 s27, s27, s28
    s_mul_i32 s27, s27, 5120
    v_add_u32 v3, s27, v0
    v_and_b32 v65, 0xf0, v0
    v_lshrrev_b32 v65, 1, v65
    v_sub_u32 v65, v2, v65
    v_lshlrev_b32 v67, 6, v0
    s_lshl_b32 s30, s18, 7
    s_waitcnt vmcnt(0)
    s_barrier
    s_mov_b32 s31, 0
    s_mov_b64 exec, 1
FFN_P1:
    s_sleep 20
    buffer_load_dword v4, v67, s[8:11], s30 offen sc0 sc1
    s_add_u32 s31, s31, 1
    s_waitcnt vmcnt(0)
    v_cmp_eq_u32 vcc, -1, v4
    s_cbranch_vccz FFN_P2
    s_cmp_lt_u32 s31, 0x40000
    s_cbranch_scc1 FFN_P1
FFN_P2:
    s_mov_b64 exec, 0xff
FFN_P3:
    buffer_load_dword v4, v67, s[8:11], s30 offen sc0 sc1
    s_add_u32 s31, s31, 1
    s_waitcnt vmcnt(0)
    v_cmp_eq_u32 vcc, -1, v4
    s_cbranch_vccz FFN_GO
    s_cmp_lt_u32 s31, 0x80000
    s_cbranch_scc1 FFN_P3
FFN_GO:
    s_mov_b64 exec, -1
    s_setprio 3
    buffer_load_dwordx4 v[4:7], v2, s[8:11], 0 offen offset:0
    buffer_load_dwordx4 v[8:11], v2, s[8:11], 0 offen offset:256
    buffer_load_dwordx4 v[12:15], v2, s[8:11], 0 offen offset:2048
    buffer_load_dwordx4 v[16:19], v2, s[8:11], 0 offen offset:2304
    s_movk_i32 s29, 4096
    buffer_load_dwordx4 v[20:23], v2, s[8:11], s29 offen offset:0
    buffer_load_dwordx4 v[24:27], v2, s[8:11], s29 offen offset:256
    buffer_load_dwordx4 v[28:31], v2, s[8:11], s29 offen offset:2048
    buffer_load_dwordx4 v[32:35], v2, s[8:11], s29 offen offset:2304
    buffer_load_dwordx2 v[36:37], v65, s[8:11], s33 offen offset:0
    buffer_load_dwordx2 v[38:39], v65, s[8:11], s33 offen offset:256
    buffer_load_dwordx2 v[40:41], v65, s[8:11], s33 offen offset:128
    buffer_load_dwordx2 v[42:43], v65, s[8:11], s33 offen offset:384
    s_waitcnt vmcnt(10)
L_oc_7:
    v_max3_u32 v67, v4, v5, v6
    v_max3_u32 v67, v67, v7, v8
    v_max3_u32 v67, v67, v9, v10
    v_max_u32 v67, v67, v11
    v_cmp_eq_u32 vcc, -1, v67
    s_cbranch_vccz L_oo_8
    s_add_u32 s31, s31, 1
    s_cmp_ge_u32 s31, 0xc0000
    s_cbranch_scc1 L_oo_8
    buffer_load_dwordx4 v[4:7], v2, s[8:11], 0 offen offset:0 sc1
    buffer_load_dwordx4 v[8:11], v2, s[8:11], 0 offen offset:256 sc1
    s_waitcnt vmcnt(0)
    s_branch L_oc_7
L_oo_8:
    v_mfma_f32_16x16x32_bf16 v[68:71], v[44:47], v[4:7], 0
    v_mfma_f32_16x16x32_bf16 v[88:91], v[44:47], v[8:11], 0
    ds_read_b128 v[44:47], v66 offset:0
    v_mfma_f32_16x16x32_bf16 v[72:75], v[48:51], v[4:7], 0
    v_mfma_f32_16x16x32_bf16 v[92:95], v[48:51], v[8:11], 0
    ds_read_b128 v[48:51], v66 offset:1024
    v_mfma_f32_16x16x32_bf16 v[76:79], v[52:55], v[4:7], 0
    v_mfma_f32_16x16x32_bf16 v[96:99], v[52:55], v[8:11], 0
    ds_read_b128 v[52:55], v66 offset:2048
    v_mfma_f32_16x16x32_bf16 v[80:83], v[56:59], v[4:7], 0
    v_mfma_f32_16x16x32_bf16 v[100:103], v[56:59], v[8:11], 0
    ds_read_b128 v[56:59], v66 offset:3072
    v_mfma_f32_16x16x32_bf16 v[84:87], v[60:63], v[4:7], 0
    v_mfma_f32_16x16x32_bf16 v[104:107], v[60:63], v[8:11], 0
    ds_read_b128 v[60:63], v66 offset:4096
    s_waitcnt vmcnt(8)
L_oc_9:
    v_max3_u32 v67, v12, v13, v14
    v_max3_u32 v67, v67, v15, v16
    v_max3_u32 v67, v67, v17, v18
    v_max_u32 v67, v67, v19
    v_cmp_eq_u32 vcc, -1, v67
    s_cbranch_vccz L_oo_10
    s_add_u32 s31, s31, 1
    s_cmp_ge_u32 s31, 0xc0000
    s_cbranch_scc1 L_oo_10
    buffer_load_dwordx4 v[12:15], v2, s[8:11], 0 offen offset:2048 sc1
    buffer_load_dwordx4 v[16:19], v2, s[8:11], 0 offen offset:2304 sc1
    s_waitcnt vmcnt(0)
    s_branch L_oc_9
L_oo_10:
    s_waitcnt lgkmcnt(4)
    v_mfma_f32_16x16x32_bf16 v[68:71], v[44:47], v[12:15], v[68:71]
    v_mfma_f32_16x16x32_bf16 v[88:91], v[44:47], v[16:19], v[88:91]
    ds_read_b128 v[44:47], v66 offset:5120
    s_waitcnt lgkmcnt(4)
    v_mfma_f32_16x16x32_bf16 v[72:75], v[48:51], v[12:15], v[72:75]
    v_mfma_f32_16x16x32_bf16 v[92:95], v[48:51], v[16:19], v[92:95]
    ds_read_b128 v[48:51], v66 offset:6144
    s_waitcnt lgkmcnt(4)
    v_mfma_f32_16x16x32_bf16 v[76:79], v[52:55], v[12:15], v[76:79]
    v_mfma_f32_16x16x32_bf16 v[96:99], v[52:55], v[16:19], v[96:99]
    ds_read_b128 v[52:55], v66 offset:7168
    s_waitcnt lgkmcnt(4)
    v_mfma_f32_16x16x32_bf16 v[80:83], v[56:59], v[12:15], v[80:83]
    v_mfma_f32_16x16x32_bf16 v[100:103], v[56:59], v[16:19], v[100:103]
    ds_read_b128 v[56:59], v66 offset:8192
    s_waitcnt lgkmcnt(4)
    v_mfma_f32_16x16x32_bf16 v[84:87], v[60:63], v[12:15], v[84:87]
    v_mfma_f32_16x16x32_bf16 v[104:107], v[60:63], v[16:19], v[104:107]
    ds_read_b128 v[60:63], v66 offset:9216
    s_waitcnt vmcnt(6)
L_oc_11:
    v_max3_u32 v67, v20, v21, v22
    v_max3_u32 v67, v67, v23, v24
    v_max3_u32 v67, v67, v25, v26
    v_max_u32 v67, v67, v27
    v_cmp_eq_u32 vcc, -1, v67
    s_cbranch_vccz L_oo_12
    s_add_u32 s31, s31, 1
    s_cmp_ge_u32 s31, 0xc0000
    s_cbranch_scc1 L_oo_12
    s_movk_i32 s29, 4096
    buffer_load_dwordx4 v[20:23], v2, s[8:11], s29 offen offset:0 sc1
    buffer_load_dwordx4 v[24:27], v2, s[8:11], s29 offen offset:256 sc1
    s_waitcnt vmcnt(0)
    s_branch L_oc_11
L_oo_12:
    s_waitcnt lgkmcnt(4)
    v_mfma_f32_16x16x32_bf16 v[68:71], v[44:47], v[20:23], v[68:71]
    v_mfma_f32_16x16x32_bf16 v[88:91], v[44:47], v[24:27], v[88:91]
    ds_read_b128 v[44:47], v66 offset:10240
    s_waitcnt lgkmcnt(4)
    v_mfma_f32_16x16x32_bf16 v[72:75], v[48:51], v[20:23], v[72:75]
    v_mfma_f32_16x16x32_bf16 v[92:95], v[48:51], v[24:27], v[92:95]
    ds_read_b128 v[48:51], v66 offset:11264
    s_waitcnt lgkmcnt(4)
    v_mfma_f32_16x16x32_bf16 v[76:79], v[52:55], v[20:23], v[76:79]
    v_mfma_f32_16x16x32_bf16 v[96:99], v[52:55], v[24:27], v[96:99]
    ds_read_b128 v[52:55], v66 offset:12288
    s_waitcnt lgkmcnt(4)
    v_mfma_f32_16x16x32_bf16 v[80:83], v[56:59], v[20:23], v[80:83]
    v_mfma_f32_16x16x32_bf16 v[100:103], v[56:59], v[24:27], v[100:103]
    ds_read_b128 v[56:59], v66 offset:13312
    s_waitcnt lgkmcnt(4)
    v_mfma_f32_16x16x32_bf16 v[84:87], v[60:63], v[20:23], v[84:87]
    v_mfma_f32_16x16x32_bf16 v[104:107], v[60:63], v[24:27], v[104:107]
    ds_read_b128 v[60:63], v66 offset:14336
    s_waitcnt vmcnt(4)
L_oc_13:
    v_max3_u32 v67, v28, v29, v30
    v_max3_u32 v67, v67, v31, v32
    v_max3_u32 v67, v67, v33, v34
    v_max_u32 v67, v67, v35
    v_cmp_eq_u32 vcc, -1, v67
    s_cbranch_vccz L_oo_14
    s_add_u32 s31, s31, 1
    s_cmp_ge_u32 s31, 0xc0000
    s_cbranch_scc1 L_oo_14
    s_movk_i32 s29, 4096
    buffer_load_dwordx4 v[28:31], v2, s[8:11], s29 offen offset:2048 sc1
    buffer_load_dwordx4 v[32:35], v2, s[8:11], s29 offen offset:2304 sc1
    s_waitcnt vmcnt(0)
    s_branch L_oc_13
L_oo_14:
    s_waitcnt lgkmcnt(4)
    v_mfma_f32_16x16x32_bf16 v[68:71], v[44:47], v[28:31], v[68:71]
    v_mfma_f32_16x16x32_bf16 v[88:91], v[44:47], v[32:35], v[88:91]
    ds_read_b128 v[44:47], v66 offset:15360
    s_waitcnt lgkmcnt(4)
    v_mfma_f32_16x16x32_bf16 v[72:75], v[48:51], v[28:31], v[72:75]
    v_mfma_f32_16x16x32_bf16 v[92:95], v[48:51], v[32:35], v[92:95]
    ds_read_b128 v[48:51], v66 offset:16384
    s_waitcnt lgkmcnt(4)
    v_mfma_f32_16x16x32_bf16 v[76:79], v[52:55], v[28:31], v[76:79]
    v_mfma_f32_16x16x32_bf16 v[96:99], v[52:55], v[32:35], v[96:99]
    ds_read_b128 v[52:55], v66 offset:17408
    s_waitcnt lgkmcnt(4)
    v_mfma_f32_16x16x32_bf16 v[80:83], v[56:59], v[28:31], v[80:83]
    v_mfma_f32_16x16x32_bf16 v[100:103], v[56:59], v[32:35], v[100:103]
    ds_read_b128 v[56:59], v66 offset:18432
    s_waitcnt lgkmcnt(4)
    v_mfma_f32_16x16x32_bf16 v[84:87], v[60:63], v[28:31], v[84:87]
    v_mfma_f32_16x16x32_bf16 v[104:107], v[60:63], v[32:35], v[104:107]
    ds_read_b128 v[60:63], v66 offset:19456
    s_waitcnt vmcnt(0)
L_oc_15:
    v_max3_u32 v67, v36, v37, v38
    v_max3_u32 v67, v67, v39, v40
    v_max3_u32 v67, v67, v41, v42
    v_max_u32 v67, v67, v43
    v_cmp_eq_u32 vcc, -1, v67
    s_cbranch_vccz L_oo_16
    s_add_u32 s31, s31, 1
    s_cmp_ge_u32 s31, 0xc0000
    s_cbranch_scc1 L_oo_16
    buffer_load_dwordx2 v[36:37], v65, s[8:11], s33 offen offset:0 sc1
    buffer_load_dwordx2 v[38:39], v65, s[8:11], s33 offen offset:256 sc1
    buffer_load_dwordx2 v[40:41], v65, s[8:11], s33 offen offset:128 sc1
    buffer_load_dwordx2 v[42:43], v65, s[8:11], s33 offen offset:384 sc1
    s_waitcnt vmcnt(0)
    s_branch L_oc_15
L_oo_16:
    s_waitcnt lgkmcnt(4)
    v_mfma_f32_16x16x32_bf16 v[68:71], v[44:47], v[36:39], v[68:71]
    v_mfma_f32_16x16x32_bf16 v[88:91], v[44:47], v[40:43], v[88:91]
    s_waitcnt lgkmcnt(3)
    v_mfma_f32_16x16x32_bf16 v[72:75], v[48:51], v[36:39], v[72:75]
    v_mfma_f32_16x16x32_bf16 v[92:95], v[48:51], v[40:43], v[92:95]
    s_waitcnt lgkmcnt(2)
    v_mfma_f32_16x16x32_bf16 v[76:79], v[52:55], v[36:39], v[76:79]
    v_mfma_f32_16x16x32_bf16 v[96:99], v[52:55], v[40:43], v[96:99]
    s_waitcnt lgkmcnt(1)
    v_mfma_f32_16x16x32_bf16 v[80:83], v[56:59], v[36:39], v[80:83]
    v_mfma_f32_16x16x32_bf16 v[100:103], v[56:59], v[40:43], v[100:103]
    s_waitcnt lgkmcnt(0)
    v_mfma_f32_16x16x32_bf16 v[84:87], v[60:63], v[36:39], v[84:87]
    v_mfma_f32_16x16x32_bf16 v[104:107], v[60:63], v[40:43], v[104:107]
    s_barrier
    s_nop 7
    s_cmp_eq_u32 s22, 0
    s_cbranch_scc1 L_fy_17
    ds_write_b128 v1, v[68:71] offset:0
    ds_write_b128 v1, v[72:75] offset:1024
    ds_write_b128 v1, v[76:79] offset:2048
    ds_write_b128 v1, v[80:83] offset:3072
    ds_write_b128 v1, v[84:87] offset:4096
L_fy_17:
    s_cmp_eq_u32 s22, 1
    s_cbranch_scc1 L_fy_18
    ds_write_b128 v3, v[88:91] offset:0
    ds_write_b128 v3, v[92:95] offset:1024
    ds_write_b128 v3, v[96:99] offset:2048
    ds_write_b128 v3, v[100:103] offset:3072
    ds_write_b128 v3, v[104:107] offset:4096
L_fy_18:
    s_waitcnt lgkmcnt(0)
    s_barrier
    s_cmp_ge_u32 s22, 2
    s_cbranch_scc1 FFN_TAIL
    s_mul_i32 s27, s24, 15360
    v_add_u32 v3, s27, v0
    ds_read_b128 v[4:7], v3 offset:0
    ds_read_b128 v[8:11], v3 offset:1024
    ds_read_b128 v[12:15], v3 offset:2048
    ds_read_b128 v[16:19], v3 offset:3072
    ds_read_b128 v[20:23], v3 offset:4096
    ds_read_b128 v[24:27], v3 offset:5120
    ds_read_b128 v[28:31], v3 offset:6144
    ds_read_b128 v[32:35], v3 offset:7168
    ds_read_b128 v[36:39], v3 offset:8192
    ds_read_b128 v[40:43], v3 offset:9216
    ds_read_b128 v[44:47], v3 offset:10240
    ds_read_b128 v[48:51], v3 offset:11264
    ds_read_b128 v[52:55], v3 offset:12288
    ds_read_b128 v[56:59], v3 offset:13312
    ds_read_b128 v[60:63], v3 offset:14336
    s_cmp_eq_u32 s22, 0
    s_cbranch_scc1 FFN_OWN1
    v_mov_b32 v68, v88
    v_mov_b32 v69, v89
    v_mov_b32 v70, v90
    v_mov_b32 v71, v91
    v_mov_b32 v72, v92
    v_mov_b32 v73, v93
    v_mov_b32 v74, v94
    v_mov_b32 v75, v95
    v_mov_b32 v76, v96
    v_mov_b32 v77, v97
    v_mov_b32 v78, v98
    v_mov_b32 v79, v99
    v_mov_b32 v80, v100
    v_mov_b32 v81, v101
    v_mov_b32 v82, v102
    v_mov_b32 v83, v103
    v_mov_b32 v84, v104
    v_mov_b32 v85, v105
    v_mov_b32 v86, v106
    v_mov_b32 v87, v107
FFN_OWN1:
    s_mov_b32 s12, s38
    s_mov_b32 s13, s39
    s_mov_b32 s14, 2621440
    s_mov_b32 s15, 0x00020000
    s_waitcnt lgkmcnt(10)
    v_add_f32 v68, v68, v4
    v_add_f32 v69, v69, v5
    v_add_f32 v70, v70, v6
    v_add_f32 v71, v71, v7
    v_add_f32 v72, v72, v8
    v_add_f32 v73, v73, v9
    v_add_f32 v74, v74, v10
    v_add_f32 v75, v75, v11
    v_add_f32 v76, v76, v12
    v_add_f32 v77, v77, v13
    v_add_f32 v78, v78, v14
    v_add_f32 v79, v79, v15
    v_add_f32 v80, v80, v16
    v_add_f32 v81, v81, v17
    v_add_f32 v82, v82, v18
    v_add_f32 v83, v83, v19
    v_add_f32 v84, v84, v20
    v_add_f32 v85, v85, v21
    v_add_f32 v86, v86, v22
    v_add_f32 v87, v87, v23
    s_waitcnt lgkmcnt(5)
    v_add_f32 v68, v68, v24
    v_add_f32 v69, v69, v25
    v_add_f32 v70, v70, v26
    v_add_f32 v71, v71, v27
    v_add_f32 v72, v72, v28
    v_add_f32 v73, v73, v29
    v_add_f32 v74, v74, v30
    v_add_f32 v75, v75, v31
    v_add_f32 v76, v76, v32
    v_add_f32 v77, v77, v33
    v_add_f32 v78, v78, v34
    v_add_f32 v79, v79, v35
    v_add_f32 v80, v80, v36
    v_add_f32 v81, v81, v37
    v_add_f32 v82, v82, v38
    v_add_f32 v83, v83, v39
    v_add_f32 v84, v84, v40
    v_add_f32 v85, v85, v41
    v_add_f32 v86, v86, v42
    v_add_f32 v87, v87, v43
    v_lshlrev_b32 v88, 16, v108
    v_and_b32 v89, 0xffff0000, v108
    v_lshlrev_b32 v4, 16, v118
    v_and_b32 v5, 0xffff0000, v118
    v_lshlrev_b32 v90, 16, v109
    v_and_b32 v91, 0xffff0000, v109
    v_lshlrev_b32 v6, 16, v119
    v_and_b32 v7, 0xffff0000, v119
    v_lshlrev_b32 v92, 16, v110
    v_and_b32 v93, 0xffff0000, v110
    v_lshlrev_b32 v8, 16, v120
    v_and_b32 v9, 0xffff0000, v120
    v_lshlrev_b32 v94, 16, v111
    v_and_b32 v95, 0xffff0000, v111
    v_lshlrev_b32 v10, 16, v121
    v_and_b32 v11, 0xffff0000, v121
    v_lshlrev_b32 v96, 16, v112
    v_and_b32 v97, 0xffff0000, v112
    v_lshlrev_b32 v12, 16, v122
    v_and_b32 v13, 0xffff0000, v122
    v_lshlrev_b32 v98, 16, v113
    v_and_b32 v99, 0xffff0000, v113
    v_lshlrev_b32 v14, 16, v123
    v_and_b32 v15, 0xffff0000, v123
    v_lshlrev_b32 v100, 16, v114
    v_and_b32 v101, 0xffff0000, v114
    v_lshlrev_b32 v16, 16, v124
    v_and_b32 v17, 0xffff0000, v124
    v_lshlrev_b32 v102, 16, v115
    v_and_b32 v103, 0xffff0000, v115
    v_lshlrev_b32 v18, 16, v125
    v_and_b32 v19, 0xffff0000, v125
    v_lshlrev_b32 v104, 16, v116
    v_and_b32 v105, 0xffff0000, v116
    v_lshlrev_b32 v20, 16, v126
    v_and_b32 v21, 0xffff0000, v126
    v_lshlrev_b32 v106, 16, v117
    v_and_b32 v107, 0xffff0000, v117
    v_lshlrev_b32 v22, 16, v127
    v_and_b32 v23, 0xffff0000, v127
    s_waitcnt lgkmcnt(0)
    v_add_f32 v68, v68, v44
    v_add_f32 v69, v69, v45
    v_add_f32 v70, v70, v46
    v_add_f32 v71, v71, v47
    v_add_f32 v72, v72, v48
    v_add_f32 v73, v73, v49
    v_add_f32 v74, v74, v50
    v_add_f32 v75, v75, v51
    v_add_f32 v76, v76, v52
    v_add_f32 v77, v77, v53
    v_add_f32 v78, v78, v54
    v_add_f32 v79, v79, v55
    v_add_f32 v80, v80, v56
    v_add_f32 v81, v81, v57
    v_add_f32 v82, v82, v58
    v_add_f32 v83, v83, v59
    v_add_f32 v84, v84, v60
    v_add_f32 v85, v85, v61
    v_add_f32 v86, v86, v62
    v_add_f32 v87, v87, v63
    v_bfe_u32 v64, v0, 4, 4
    v_lshrrev_b32 v65, 8, v0
    v_mul_u32_u24 v64, 1280, v64
    v_lshlrev_b32 v65, 3, v65
    v_add_u32 v3, v64, v65
    v_add_u32 v64, v3, v65
    v_add_u32 v65, 128, v3
    v_fma_f32 v68, v68, v88, v4
    v_fma_f32 v69, v69, v89, v5
    v_fma_f32 v70, v70, v90, v6
    v_fma_f32 v71, v71, v91, v7
    v_fma_f32 v72, v72, v92, v8
    v_fma_f32 v73, v73, v93, v9
    v_fma_f32 v74, v74, v94, v10
    v_fma_f32 v75, v75, v95, v11
    v_fma_f32 v76, v76, v96, v12
    v_fma_f32 v77, v77, v97, v13
    v_fma_f32 v78, v78, v98, v14
    v_fma_f32 v79, v79, v99, v15
    v_fma_f32 v80, v80, v100, v16
    v_fma_f32 v81, v81, v101, v17
    v_fma_f32 v82, v82, v102, v18
    v_fma_f32 v83, v83, v103, v19
    v_fma_f32 v84, v84, v104, v20
    v_fma_f32 v85, v85, v105, v21
    v_fma_f32 v86, v86, v106, v22
    v_fma_f32 v87, v87, v107, v23
    v_cvt_pk_bf16_f32 v88, v68, v69
    v_cvt_pk_bf16_f32 v89, v70, v71
    v_cvt_pk_bf16_f32 v90, v72, v73
    v_cvt_pk_bf16_f32 v91, v74, v75
    v_cvt_pk_bf16_f32 v92, v76, v77
    v_cvt_pk_bf16_f32 v93, v78, v79
    v_cvt_pk_bf16_f32 v94, v80, v81
    v_cvt_pk_bf16_f32 v95, v82, v83
    v_cvt_pk_bf16_f32 v96, v84, v85
    v_cvt_pk_bf16_f32 v97, v86, v87
    buffer_store_dwordx4 v[88:91], v64, s[12:15], s26 offen nt
    buffer_store_dwordx4 v[92:95], v64, s[12:15], s26 offen offset:64 nt
    buffer_store_dwordx2 v[96:97], v65, s[12:15], s26 offen nt
    s_waitcnt vmcnt(0)
    s_endpgm
FFN_TAIL:
    s_endpgm

.section .rodata,"a"
.p2align 6
.amdhsa_kernel k1_kernel
  .amdhsa_next_free_vgpr 256
  .amdhsa_next_free_sgpr 102
  .amdhsa_accum_offset 256
  .amdhsa_group_segment_fixed_size 0
  .amdhsa_kernarg_size 80
  .amdhsa_user_sgpr_count 2
  .amdhsa_user_sgpr_kernarg_segment_ptr 1
  .amdhsa_system_sgpr_workgroup_id_x 1
.end_amdhsa_kernel

.amdhsa_kernel att_kernel
  .amdhsa_next_free_vgpr 128
  .amdhsa_next_free_sgpr 102
  .amdhsa_accum_offset 128
  .amdhsa_group_segment_fixed_size 0
  .amdhsa_kernarg_size 80
  .amdhsa_user_sgpr_count 2
  .amdhsa_user_sgpr_kernarg_segment_ptr 1
  .amdhsa_system_sgpr_workgroup_id_x 1
.end_amdhsa_kernel
```
